```python
import torch

def _softmax(x, axis=-1):
    return torch.softmax(x, dim=axis)
def _gelu(x):
    return torch.nn.functional.gelu(x, approximate="tanh")
def _silu(x):
    return torch.nn.functional.silu(x)
def _sigmoid(x):
    return torch.sigmoid(x)
def _layernorm(x, axis=-1, eps=1e-5):
    m = x.mean(dim=axis, keepdim=True)
    v = x.var(dim=axis, keepdim=True, unbiased=False)
    return (x - m) / torch.sqrt(v + eps)
def _scatter_add(tgt, idx, src, axis=0):
    return tgt.clone().index_add_(axis, idx, src)
def _segment_sum(src, seg, n):
    out = torch.zeros((n,) + src.shape[1:], dtype=src.dtype)
    return out.index_add_(0, seg, src)
def _pad(x, pw):
    flat = tuple(v for pair in reversed(pw) for v in pair)
    return torch.nn.functional.pad(x, flat)

kernel_name = 'concat_heads__mha_block__sliding_block__prompt'

def setup_inputs():

    _w = (lambda a: (lambda t: t.to(torch.bfloat16) if t.is_floating_point() else t)(torch.as_tensor(a)))
    def _A_setup():
        B, S, D, H = 1, 2048, 640, 32
        return {
            "x": _w((lambda *s: torch.randn(*s, dtype=torch.bfloat16) * 0.2)(B, S, D)),
            "wqkv": _w((lambda *s: torch.randn(*s, dtype=torch.bfloat16) * 0.4)(D, 3 * D)),
            "wo": _w((lambda *s: torch.randn(*s, dtype=torch.bfloat16) * 0.1)(D, D)),
        }
    _A_in = _A_setup()

    def _B_setup():
        B, S, D = 1, 2048, 640
        return {
            "x": _w((lambda *s: torch.randn(*s, dtype=torch.bfloat16) * 0.4)(B, S, D)),
            "wqkv": _w((lambda *s: torch.randn(*s, dtype=torch.bfloat16) * 0.4)(D, 3 * D)),
            "wo": _w((lambda *s: torch.randn(*s, dtype=torch.bfloat16) * 0.05)(D, D)),
        }
    _B_in = _B_setup()

    return {
        "A_x": _A_in["x"],
        "A_wqkv": _A_in["wqkv"],
        "A_wo": _A_in["wo"],
        "B_x": _B_in["x"],
        "B_wqkv": _B_in["wqkv"],
        "B_wo": _B_in["wo"],
    }

def reference(A_x, A_wqkv, A_wo, B_x, B_wqkv, B_wo):
    def _A_ref(x, wqkv, wo):
        B, S, D = x.shape
        H = 32
        Dh = D // H
        qkv = (lambda x, *d: x.permute(*d))((x @ wqkv).reshape(B, S, 3, H, Dh), 2, 0, 3, 1, 4)
        q, k, v = qkv[0], qkv[1], qkv[2]
        scores = torch.einsum("bhqd,bhkd->bhqk", q, k) * (Dh ** -0.5)
        p = _softmax(scores, axis=-1)
        o = torch.einsum("bhqk,bhkd->bhqd", p, v)
        return (lambda x, *d: x.permute(*d))(o, 0, 2, 1, 3).reshape(B, S, D) @ wo

    def _B_ref(x, wqkv, wo):
        B, S, D = x.shape
        H = 32; Dh = D // H; W = 256
        qkv = (lambda x, *d: x.permute(*d))((x @ wqkv).reshape(B, S, 3, H, Dh), 2, 0, 3, 1, 4)
        q, k, v = qkv[0], qkv[1], qkv[2]
        scores = torch.einsum("bhqd,bhkd->bhqk", q, k) * (Dh ** -0.5)
        idx = torch.arange(S)
        mask = (idx[:, None] - idx[None, :] >= 0) & (idx[:, None] - idx[None, :] < W)
        scores = torch.where(mask[None, None], scores, -1e9)
        p = _softmax(scores, axis=-1)
        o = torch.einsum("bhqk,bhkd->bhqd", p, v)
        return (lambda x, *d: x.permute(*d))(o, 0, 2, 1, 3).reshape(B, S, D) @ wo

    a = _A_ref(A_x, A_wqkv, A_wo)
    b = _B_ref(B_x, B_wqkv, B_wo)
    return torch.concatenate([a, b], axis=-1)
```

```asm
; @launch kernel=qkv_kernel grid=(256,1,1) block=(512,1,1) lds=147456
; @launch kernel=attn_kernel grid=(256,1,1) block=(512,1,1) lds=163840
; @launch kernel=oproj_kernel grid=(256,1,1) block=(640,1,1) lds=122880
.amdgcn_target "amdgcn-amd-amdhsa--gfx950"
.text
.globl qkv_kernel
.p2align 8
.type qkv_kernel,@function
qkv_kernel:
  s_cmp_ge_u32 s2, 256
  s_cbranch_scc1 L_qkv_kernel_end
  s_load_dwordx8 s[4:11], s[0:1], 0
  s_load_dwordx4 s[12:15], s[0:1], 32
  s_load_dwordx2 s[16:17], s[0:1], 64
  v_lshrrev_b32 v1, 6, v0
  v_and_b32 v0, 63, v0
  s_and_b32 s20, s2, 1
  v_readfirstlane_b32 s23, v1
  s_lshr_b32 s18, s2, 3
  s_and_b32 s21, s18, 3
  s_and_b32 s19, s2, 2
  s_lshl_b32 s19, s19, 1
  s_add_u32 s21, s21, s19
  s_lshr_b32 s22, s18, 2
  s_and_b32 s19, s2, 4
  s_lshl_b32 s19, s19, 1
  s_add_u32 s22, s22, s19
  s_cmp_eq_u32 s22, 15
  s_cbranch_scc1 L_qkv_kernel_wot
  s_cmp_ge_u32 s23, 4
  s_cbranch_scc0 L_qkv_kernel_compute
  s_sub_u32 s23, s23, 4
  v_lshrrev_b32 v8, 4, v0
  v_and_b32 v7, 15, v0
  v_lshlrev_b32 v9, 2, v8
  v_xor_b32 v7, v7, v9
  v_mul_u32_u24 v9, 3840, v8
  v_lshl_add_u32 v2, v7, 4, v9
  v_lshrrev_b32 v6, 3, v0
  v_mul_u32_u24 v6, 1280, v6
  v_and_b32 v7, 7, v0
  v_add_u32 v9, 0, v8
  v_xor_b32 v9, v9, v7
  v_lshl_add_u32 v4, v9, 4, v6
  v_add_u32 v9, 4, v8
  v_xor_b32 v9, v9, v7
  v_lshl_add_u32 v5, v9, 4, v6
  s_mul_i32 s44, s23, 61440
  s_lshl_b32 s45, s22, 8
  s_add_u32 s44, s44, s45
  s_lshl_b32 s45, s21, 8
  s_lshl_b32 s46, s23, 6
  s_add_u32 s45, s45, s46
  s_mul_i32 s45, s45, 1280
  s_lshl_b32 s47, s23, 13
  s_lshl_b32 s46, s23, 12
  s_add_u32 s46, s46, 32768
  s_mov_b32 s48, 0
  s_mov_b32 s49, 0
  s_waitcnt lgkmcnt(0)
  s_cmp_eq_u32 s20, 0
  s_cselect_b32 s24, s4, s10
  s_cselect_b32 s25, s5, s11
  s_cselect_b32 s28, s6, s12
  s_cselect_b32 s29, s7, s13
  s_mov_b32 s26, 0x280000
  s_mov_b32 s27, 0x20000
  s_mov_b32 s30, 0x258000
  s_mov_b32 s31, 0x20000
  s_add_u32 s50, s48, s46
  s_add_u32 s51, s48, s47
  s_add_u32 m0, s50, 0
  s_add_u32 s52, s44, 0
  buffer_load_dwordx4 v2, s[28:31], s52 offen lds
  s_add_u32 m0, s50, 1024
  s_add_u32 s52, s44, 15360
  buffer_load_dwordx4 v2, s[28:31], s52 offen lds
  s_add_u32 m0, s50, 2048
  s_add_u32 s52, s44, 30720
  buffer_load_dwordx4 v2, s[28:31], s52 offen lds
  s_add_u32 m0, s50, 3072
  s_add_u32 s52, s44, 46080
  buffer_load_dwordx4 v2, s[28:31], s52 offen lds
  s_add_u32 m0, s51, 0
  s_add_u32 s52, s45, 0
  buffer_load_dwordx4 v4, s[24:27], s52 offen lds
  s_add_u32 m0, s51, 1024
  s_add_u32 s52, s45, 10240
  buffer_load_dwordx4 v5, s[24:27], s52 offen lds
  s_add_u32 m0, s51, 2048
  s_add_u32 s52, s45, 20480
  buffer_load_dwordx4 v4, s[24:27], s52 offen lds
  s_add_u32 m0, s51, 3072
  s_add_u32 s52, s45, 30720
  buffer_load_dwordx4 v5, s[24:27], s52 offen lds
  s_add_u32 m0, s51, 4096
  s_add_u32 s52, s45, 40960
  buffer_load_dwordx4 v4, s[24:27], s52 offen lds
  s_add_u32 m0, s51, 5120
  s_add_u32 s52, s45, 51200
  buffer_load_dwordx4 v5, s[24:27], s52 offen lds
  s_add_u32 m0, s51, 6144
  s_add_u32 s52, s45, 61440
  buffer_load_dwordx4 v4, s[24:27], s52 offen lds
  s_add_u32 m0, s51, 7168
  s_add_u32 s52, s45, 71680
  buffer_load_dwordx4 v5, s[24:27], s52 offen lds
  s_add_u32 s44, s44, 245760
  s_add_u32 s45, s45, 128
  s_add_u32 s48, s48, 49152
  s_cmp_eq_u32 s48, 147456
  s_cselect_b32 s48, 0, s48
  s_add_u32 s50, s48, s46
  s_add_u32 s51, s48, s47
  s_add_u32 m0, s50, 0
  s_add_u32 s52, s44, 0
  buffer_load_dwordx4 v2, s[28:31], s52 offen lds
  s_add_u32 m0, s50, 1024
  s_add_u32 s52, s44, 15360
  buffer_load_dwordx4 v2, s[28:31], s52 offen lds
  s_add_u32 m0, s50, 2048
  s_add_u32 s52, s44, 30720
  buffer_load_dwordx4 v2, s[28:31], s52 offen lds
  s_add_u32 m0, s50, 3072
  s_add_u32 s52, s44, 46080
  buffer_load_dwordx4 v2, s[28:31], s52 offen lds
  s_add_u32 m0, s51, 0
  s_add_u32 s52, s45, 0
  buffer_load_dwordx4 v4, s[24:27], s52 offen lds
  s_add_u32 m0, s51, 1024
  s_add_u32 s52, s45, 10240
  buffer_load_dwordx4 v5, s[24:27], s52 offen lds
  s_add_u32 m0, s51, 2048
  s_add_u32 s52, s45, 20480
  buffer_load_dwordx4 v4, s[24:27], s52 offen lds
  s_add_u32 m0, s51, 3072
  s_add_u32 s52, s45, 30720
  buffer_load_dwordx4 v5, s[24:27], s52 offen lds
  s_add_u32 m0, s51, 4096
  s_add_u32 s52, s45, 40960
  buffer_load_dwordx4 v4, s[24:27], s52 offen lds
  s_add_u32 m0, s51, 5120
  s_add_u32 s52, s45, 51200
  buffer_load_dwordx4 v5, s[24:27], s52 offen lds
  s_add_u32 m0, s51, 6144
  s_add_u32 s52, s45, 61440
  buffer_load_dwordx4 v4, s[24:27], s52 offen lds
  s_add_u32 m0, s51, 7168
  s_add_u32 s52, s45, 71680
  buffer_load_dwordx4 v5, s[24:27], s52 offen lds
  s_waitcnt vmcnt(12)
  s_barrier
  s_add_u32 s44, s44, 245760
  s_add_u32 s45, s45, 128
  s_add_u32 s48, s48, 49152
  s_cmp_eq_u32 s48, 147456
  s_cselect_b32 s48, 0, s48
  s_mov_b32 s49, 2
  s_branch L_qkv_kernel_ld_issue
L_qkv_kernel_ld_loop:
  s_waitcnt vmcnt(12)
  s_barrier
L_qkv_kernel_ld_issue:
  s_add_u32 s50, s48, s46
  s_add_u32 s51, s48, s47
  s_add_u32 m0, s50, 0
  s_add_u32 s52, s44, 0
  buffer_load_dwordx4 v2, s[28:31], s52 offen lds
  s_add_u32 m0, s50, 1024
  s_add_u32 s52, s44, 15360
  buffer_load_dwordx4 v2, s[28:31], s52 offen lds
  s_add_u32 m0, s50, 2048
  s_add_u32 s52, s44, 30720
  buffer_load_dwordx4 v2, s[28:31], s52 offen lds
  s_add_u32 m0, s50, 3072
  s_add_u32 s52, s44, 46080
  buffer_load_dwordx4 v2, s[28:31], s52 offen lds
  s_add_u32 m0, s51, 0
  s_add_u32 s52, s45, 0
  buffer_load_dwordx4 v4, s[24:27], s52 offen lds
  s_add_u32 m0, s51, 1024
  s_add_u32 s52, s45, 10240
  buffer_load_dwordx4 v5, s[24:27], s52 offen lds
  s_add_u32 m0, s51, 2048
  s_add_u32 s52, s45, 20480
  buffer_load_dwordx4 v4, s[24:27], s52 offen lds
  s_add_u32 m0, s51, 3072
  s_add_u32 s52, s45, 30720
  buffer_load_dwordx4 v5, s[24:27], s52 offen lds
  s_add_u32 m0, s51, 4096
  s_add_u32 s52, s45, 40960
  buffer_load_dwordx4 v4, s[24:27], s52 offen lds
  s_add_u32 m0, s51, 5120
  s_add_u32 s52, s45, 51200
  buffer_load_dwordx4 v5, s[24:27], s52 offen lds
  s_add_u32 m0, s51, 6144
  s_add_u32 s52, s45, 61440
  buffer_load_dwordx4 v4, s[24:27], s52 offen lds
  s_add_u32 m0, s51, 7168
  s_add_u32 s52, s45, 71680
  buffer_load_dwordx4 v5, s[24:27], s52 offen lds
  s_add_u32 s44, s44, 245760
  s_add_u32 s45, s45, 128
  s_add_u32 s48, s48, 49152
  s_cmp_eq_u32 s48, 147456
  s_cselect_b32 s48, 0, s48
  s_add_u32 s49, s49, 1
  s_cmp_lt_u32 s49, 10
  s_cbranch_scc1 L_qkv_kernel_ld_loop
  s_waitcnt vmcnt(12)
  s_barrier
  s_waitcnt vmcnt(0)
  s_barrier
  s_endpgm
L_qkv_kernel_wot:
  s_and_b32 s44, s2, 3
  s_lshl_b32 s44, s44, 2
  s_and_b32 s45, s18, 3
  s_add_u32 s44, s44, s45
  s_lshl_b32 s44, s44, 3
  s_add_u32 s44, s44, s23
  v_and_b32 v6, 31, v0
  v_and_b32 v7, 3, v6
  v_lshrrev_b32 v8, 3, v6
  v_lshl_add_u32 v7, v8, 2, v7
  v_and_b32 v8, 4, v6
  v_lshl_add_u32 v7, v8, 2, v7
  v_lshlrev_b32 v7, 1, v7
  v_lshrrev_b32 v8, 5, v0
  v_mul_u32_u24 v8, 2560, v8
  v_add_u32 v11, v7, v8
  v_add_u32 v10, v11, v8
  v_lshlrev_b32 v6, 4, v0
  s_mov_b32 s38, 0xc8000
  s_mov_b32 s39, 0x20000
  s_waitcnt lgkmcnt(0)
  s_add_u32 s40, s16, 0x1600000
  s_addc_u32 s41, s17, 0
  s_mov_b32 s42, 0x190000
  s_mov_b32 s43, 0x20000
L_qkv_kernel_wotl:
  s_add_u32 s53, s44, 0
  s_cmp_lt_u32 s53, 400
  s_cselect_b32 s36, s8, s14
  s_cselect_b32 s37, s9, s15
  s_cselect_b32 s45, 0, 400
  s_sub_u32 s45, s53, s45
  s_mul_i32 s46, s45, 3277
  s_lshr_b32 s46, s46, 16
  s_mul_i32 s47, s46, 20
  s_sub_u32 s47, s45, s47
  s_lshl_b32 s50, s46, 6
  s_cmp_lt_u32 s47, 16
  s_cbranch_scc0 L_qkv_kernel_wo2_0
  s_mul_i32 s51, s47, 51200
  s_add_u32 s50, s50, s51
  s_add_u32 s52, s50, 0
  buffer_load_ushort v32, v10, s[36:39], s52 offen offset:0
  buffer_load_ushort v33, v10, s[36:39], s52 offen offset:1280
  buffer_load_ushort v34, v10, s[36:39], s52 offen offset:2560
  buffer_load_ushort v35, v10, s[36:39], s52 offen offset:3840
  s_add_u32 s52, s50, 10240
  buffer_load_ushort v36, v10, s[36:39], s52 offen offset:0
  buffer_load_ushort v37, v10, s[36:39], s52 offen offset:1280
  buffer_load_ushort v38, v10, s[36:39], s52 offen offset:2560
  buffer_load_ushort v39, v10, s[36:39], s52 offen offset:3840
  s_add_u32 s52, s50, 25600
  buffer_load_ushort v40, v10, s[36:39], s52 offen offset:0
  buffer_load_ushort v41, v10, s[36:39], s52 offen offset:1280
  buffer_load_ushort v42, v10, s[36:39], s52 offen offset:2560
  buffer_load_ushort v43, v10, s[36:39], s52 offen offset:3840
  s_add_u32 s52, s50, 35840
  buffer_load_ushort v44, v10, s[36:39], s52 offen offset:0
  buffer_load_ushort v45, v10, s[36:39], s52 offen offset:1280
  buffer_load_ushort v46, v10, s[36:39], s52 offen offset:2560
  buffer_load_ushort v47, v10, s[36:39], s52 offen offset:3840
  s_branch L_qkv_kernel_wo3_0
L_qkv_kernel_wo2_0:
  s_sub_u32 s51, s47, 16
  s_mul_i32 s51, s51, 204800
  s_add_u32 s50, s50, s51
  s_add_u32 s52, s50, 20480
  buffer_load_ushort v32, v11, s[36:39], s52 offen offset:0
  buffer_load_ushort v33, v11, s[36:39], s52 offen offset:1280
  s_add_u32 s52, s50, 46080
  buffer_load_ushort v34, v11, s[36:39], s52 offen offset:0
  buffer_load_ushort v35, v11, s[36:39], s52 offen offset:1280
  s_add_u32 s52, s50, 71680
  buffer_load_ushort v36, v11, s[36:39], s52 offen offset:0
  buffer_load_ushort v37, v11, s[36:39], s52 offen offset:1280
  s_add_u32 s52, s50, 97280
  buffer_load_ushort v38, v11, s[36:39], s52 offen offset:0
  buffer_load_ushort v39, v11, s[36:39], s52 offen offset:1280
  s_add_u32 s52, s50, 122880
  buffer_load_ushort v40, v11, s[36:39], s52 offen offset:0
  buffer_load_ushort v41, v11, s[36:39], s52 offen offset:1280
  s_add_u32 s52, s50, 148480
  buffer_load_ushort v42, v11, s[36:39], s52 offen offset:0
  buffer_load_ushort v43, v11, s[36:39], s52 offen offset:1280
  s_add_u32 s52, s50, 174080
  buffer_load_ushort v44, v11, s[36:39], s52 offen offset:0
  buffer_load_ushort v45, v11, s[36:39], s52 offen offset:1280
  s_add_u32 s52, s50, 199680
  buffer_load_ushort v46, v11, s[36:39], s52 offen offset:0
  buffer_load_ushort v47, v11, s[36:39], s52 offen offset:1280
L_qkv_kernel_wo3_0:
  s_add_u32 s53, s44, 128
  s_cmp_lt_u32 s53, 400
  s_cselect_b32 s36, s8, s14
  s_cselect_b32 s37, s9, s15
  s_cselect_b32 s45, 0, 400
  s_sub_u32 s45, s53, s45
  s_mul_i32 s46, s45, 3277
  s_lshr_b32 s46, s46, 16
  s_mul_i32 s47, s46, 20
  s_sub_u32 s47, s45, s47
  s_lshl_b32 s50, s46, 6
  s_cmp_lt_u32 s47, 16
  s_cbranch_scc0 L_qkv_kernel_wo2_1
  s_mul_i32 s51, s47, 51200
  s_add_u32 s50, s50, s51
  s_add_u32 s52, s50, 0
  buffer_load_ushort v48, v10, s[36:39], s52 offen offset:0
  buffer_load_ushort v49, v10, s[36:39], s52 offen offset:1280
  buffer_load_ushort v50, v10, s[36:39], s52 offen offset:2560
  buffer_load_ushort v51, v10, s[36:39], s52 offen offset:3840
  s_add_u32 s52, s50, 10240
  buffer_load_ushort v52, v10, s[36:39], s52 offen offset:0
  buffer_load_ushort v53, v10, s[36:39], s52 offen offset:1280
  buffer_load_ushort v54, v10, s[36:39], s52 offen offset:2560
  buffer_load_ushort v55, v10, s[36:39], s52 offen offset:3840
  s_add_u32 s52, s50, 25600
  buffer_load_ushort v56, v10, s[36:39], s52 offen offset:0
  buffer_load_ushort v57, v10, s[36:39], s52 offen offset:1280
  buffer_load_ushort v58, v10, s[36:39], s52 offen offset:2560
  buffer_load_ushort v59, v10, s[36:39], s52 offen offset:3840
  s_add_u32 s52, s50, 35840
  buffer_load_ushort v60, v10, s[36:39], s52 offen offset:0
  buffer_load_ushort v61, v10, s[36:39], s52 offen offset:1280
  buffer_load_ushort v62, v10, s[36:39], s52 offen offset:2560
  buffer_load_ushort v63, v10, s[36:39], s52 offen offset:3840
  s_branch L_qkv_kernel_wo3_1
L_qkv_kernel_wo2_1:
  s_sub_u32 s51, s47, 16
  s_mul_i32 s51, s51, 204800
  s_add_u32 s50, s50, s51
  s_add_u32 s52, s50, 20480
  buffer_load_ushort v48, v11, s[36:39], s52 offen offset:0
  buffer_load_ushort v49, v11, s[36:39], s52 offen offset:1280
  s_add_u32 s52, s50, 46080
  buffer_load_ushort v50, v11, s[36:39], s52 offen offset:0
  buffer_load_ushort v51, v11, s[36:39], s52 offen offset:1280
  s_add_u32 s52, s50, 71680
  buffer_load_ushort v52, v11, s[36:39], s52 offen offset:0
  buffer_load_ushort v53, v11, s[36:39], s52 offen offset:1280
  s_add_u32 s52, s50, 97280
  buffer_load_ushort v54, v11, s[36:39], s52 offen offset:0
  buffer_load_ushort v55, v11, s[36:39], s52 offen offset:1280
  s_add_u32 s52, s50, 122880
  buffer_load_ushort v56, v11, s[36:39], s52 offen offset:0
  buffer_load_ushort v57, v11, s[36:39], s52 offen offset:1280
  s_add_u32 s52, s50, 148480
  buffer_load_ushort v58, v11, s[36:39], s52 offen offset:0
  buffer_load_ushort v59, v11, s[36:39], s52 offen offset:1280
  s_add_u32 s52, s50, 174080
  buffer_load_ushort v60, v11, s[36:39], s52 offen offset:0
  buffer_load_ushort v61, v11, s[36:39], s52 offen offset:1280
  s_add_u32 s52, s50, 199680
  buffer_load_ushort v62, v11, s[36:39], s52 offen offset:0
  buffer_load_ushort v63, v11, s[36:39], s52 offen offset:1280
L_qkv_kernel_wo3_1:
  s_add_u32 s53, s44, 256
  s_cmp_ge_u32 s53, 800
  s_cbranch_scc1 L_qkv_kernel_wo3_2
  s_cmp_lt_u32 s53, 400
  s_cselect_b32 s36, s8, s14
  s_cselect_b32 s37, s9, s15
  s_cselect_b32 s45, 0, 400
  s_sub_u32 s45, s53, s45
  s_mul_i32 s46, s45, 3277
  s_lshr_b32 s46, s46, 16
  s_mul_i32 s47, s46, 20
  s_sub_u32 s47, s45, s47
  s_lshl_b32 s50, s46, 6
  s_cmp_lt_u32 s47, 16
  s_cbranch_scc0 L_qkv_kernel_wo2_2
  s_mul_i32 s51, s47, 51200
  s_add_u32 s50, s50, s51
  s_add_u32 s52, s50, 0
  buffer_load_ushort v64, v10, s[36:39], s52 offen offset:0
  buffer_load_ushort v65, v10, s[36:39], s52 offen offset:1280
  buffer_load_ushort v66, v10, s[36:39], s52 offen offset:2560
  buffer_load_ushort v67, v10, s[36:39], s52 offen offset:3840
  s_add_u32 s52, s50, 10240
  buffer_load_ushort v68, v10, s[36:39], s52 offen offset:0
  buffer_load_ushort v69, v10, s[36:39], s52 offen offset:1280
  buffer_load_ushort v70, v10, s[36:39], s52 offen offset:2560
  buffer_load_ushort v71, v10, s[36:39], s52 offen offset:3840
  s_add_u32 s52, s50, 25600
  buffer_load_ushort v72, v10, s[36:39], s52 offen offset:0
  buffer_load_ushort v73, v10, s[36:39], s52 offen offset:1280
  buffer_load_ushort v74, v10, s[36:39], s52 offen offset:2560
  buffer_load_ushort v75, v10, s[36:39], s52 offen offset:3840
  s_add_u32 s52, s50, 35840
  buffer_load_ushort v76, v10, s[36:39], s52 offen offset:0
  buffer_load_ushort v77, v10, s[36:39], s52 offen offset:1280
  buffer_load_ushort v78, v10, s[36:39], s52 offen offset:2560
  buffer_load_ushort v79, v10, s[36:39], s52 offen offset:3840
  s_branch L_qkv_kernel_wo3_2
L_qkv_kernel_wo2_2:
  s_sub_u32 s51, s47, 16
  s_mul_i32 s51, s51, 204800
  s_add_u32 s50, s50, s51
  s_add_u32 s52, s50, 20480
  buffer_load_ushort v64, v11, s[36:39], s52 offen offset:0
  buffer_load_ushort v65, v11, s[36:39], s52 offen offset:1280
  s_add_u32 s52, s50, 46080
  buffer_load_ushort v66, v11, s[36:39], s52 offen offset:0
  buffer_load_ushort v67, v11, s[36:39], s52 offen offset:1280
  s_add_u32 s52, s50, 71680
  buffer_load_ushort v68, v11, s[36:39], s52 offen offset:0
  buffer_load_ushort v69, v11, s[36:39], s52 offen offset:1280
  s_add_u32 s52, s50, 97280
  buffer_load_ushort v70, v11, s[36:39], s52 offen offset:0
  buffer_load_ushort v71, v11, s[36:39], s52 offen offset:1280
  s_add_u32 s52, s50, 122880
  buffer_load_ushort v72, v11, s[36:39], s52 offen offset:0
  buffer_load_ushort v73, v11, s[36:39], s52 offen offset:1280
  s_add_u32 s52, s50, 148480
  buffer_load_ushort v74, v11, s[36:39], s52 offen offset:0
  buffer_load_ushort v75, v11, s[36:39], s52 offen offset:1280
  s_add_u32 s52, s50, 174080
  buffer_load_ushort v76, v11, s[36:39], s52 offen offset:0
  buffer_load_ushort v77, v11, s[36:39], s52 offen offset:1280
  s_add_u32 s52, s50, 199680
  buffer_load_ushort v78, v11, s[36:39], s52 offen offset:0
  buffer_load_ushort v79, v11, s[36:39], s52 offen offset:1280
L_qkv_kernel_wo3_2:
  s_add_u32 s53, s44, 384
  s_cmp_ge_u32 s53, 800
  s_cbranch_scc1 L_qkv_kernel_wo3_3
  s_cmp_lt_u32 s53, 400
  s_cselect_b32 s36, s8, s14
  s_cselect_b32 s37, s9, s15
  s_cselect_b32 s45, 0, 400
  s_sub_u32 s45, s53, s45
  s_mul_i32 s46, s45, 3277
  s_lshr_b32 s46, s46, 16
  s_mul_i32 s47, s46, 20
  s_sub_u32 s47, s45, s47
  s_lshl_b32 s50, s46, 6
  s_cmp_lt_u32 s47, 16
  s_cbranch_scc0 L_qkv_kernel_wo2_3
  s_mul_i32 s51, s47, 51200
  s_add_u32 s50, s50, s51
  s_add_u32 s52, s50, 0
  buffer_load_ushort v80, v10, s[36:39], s52 offen offset:0
  buffer_load_ushort v81, v10, s[36:39], s52 offen offset:1280
  buffer_load_ushort v82, v10, s[36:39], s52 offen offset:2560
  buffer_load_ushort v83, v10, s[36:39], s52 offen offset:3840
  s_add_u32 s52, s50, 10240
  buffer_load_ushort v84, v10, s[36:39], s52 offen offset:0
  buffer_load_ushort v85, v10, s[36:39], s52 offen offset:1280
  buffer_load_ushort v86, v10, s[36:39], s52 offen offset:2560
  buffer_load_ushort v87, v10, s[36:39], s52 offen offset:3840
  s_add_u32 s52, s50, 25600
  buffer_load_ushort v88, v10, s[36:39], s52 offen offset:0
  buffer_load_ushort v89, v10, s[36:39], s52 offen offset:1280
  buffer_load_ushort v90, v10, s[36:39], s52 offen offset:2560
  buffer_load_ushort v91, v10, s[36:39], s52 offen offset:3840
  s_add_u32 s52, s50, 35840
  buffer_load_ushort v92, v10, s[36:39], s52 offen offset:0
  buffer_load_ushort v93, v10, s[36:39], s52 offen offset:1280
  buffer_load_ushort v94, v10, s[36:39], s52 offen offset:2560
  buffer_load_ushort v95, v10, s[36:39], s52 offen offset:3840
  s_branch L_qkv_kernel_wo3_3
L_qkv_kernel_wo2_3:
  s_sub_u32 s51, s47, 16
  s_mul_i32 s51, s51, 204800
  s_add_u32 s50, s50, s51
  s_add_u32 s52, s50, 20480
  buffer_load_ushort v80, v11, s[36:39], s52 offen offset:0
  buffer_load_ushort v81, v11, s[36:39], s52 offen offset:1280
  s_add_u32 s52, s50, 46080
  buffer_load_ushort v82, v11, s[36:39], s52 offen offset:0
  buffer_load_ushort v83, v11, s[36:39], s52 offen offset:1280
  s_add_u32 s52, s50, 71680
  buffer_load_ushort v84, v11, s[36:39], s52 offen offset:0
  buffer_load_ushort v85, v11, s[36:39], s52 offen offset:1280
  s_add_u32 s52, s50, 97280
  buffer_load_ushort v86, v11, s[36:39], s52 offen offset:0
  buffer_load_ushort v87, v11, s[36:39], s52 offen offset:1280
  s_add_u32 s52, s50, 122880
  buffer_load_ushort v88, v11, s[36:39], s52 offen offset:0
  buffer_load_ushort v89, v11, s[36:39], s52 offen offset:1280
  s_add_u32 s52, s50, 148480
  buffer_load_ushort v90, v11, s[36:39], s52 offen offset:0
  buffer_load_ushort v91, v11, s[36:39], s52 offen offset:1280
  s_add_u32 s52, s50, 174080
  buffer_load_ushort v92, v11, s[36:39], s52 offen offset:0
  buffer_load_ushort v93, v11, s[36:39], s52 offen offset:1280
  s_add_u32 s52, s50, 199680
  buffer_load_ushort v94, v11, s[36:39], s52 offen offset:0
  buffer_load_ushort v95, v11, s[36:39], s52 offen offset:1280
L_qkv_kernel_wo3_3:
  s_waitcnt vmcnt(0)
  s_add_u32 s53, s44, 0
  s_lshl_b32 s50, s53, 11
  v_lshl_or_b32 v96, v33, 16, v32
  v_lshl_or_b32 v97, v35, 16, v34
  v_lshl_or_b32 v98, v37, 16, v36
  v_lshl_or_b32 v99, v39, 16, v38
  v_lshl_or_b32 v100, v41, 16, v40
  v_lshl_or_b32 v101, v43, 16, v42
  v_lshl_or_b32 v102, v45, 16, v44
  v_lshl_or_b32 v103, v47, 16, v46
  buffer_store_dwordx4 v[96:99], v6, s[40:43], s50 offen sc1
  buffer_store_dwordx4 v[100:103], v6, s[40:43], s50 offen offset:1024 sc1
  s_add_u32 s53, s44, 128
  s_lshl_b32 s50, s53, 11
  v_lshl_or_b32 v104, v49, 16, v48
  v_lshl_or_b32 v105, v51, 16, v50
  v_lshl_or_b32 v106, v53, 16, v52
  v_lshl_or_b32 v107, v55, 16, v54
  v_lshl_or_b32 v108, v57, 16, v56
  v_lshl_or_b32 v109, v59, 16, v58
  v_lshl_or_b32 v110, v61, 16, v60
  v_lshl_or_b32 v111, v63, 16, v62
  buffer_store_dwordx4 v[104:107], v6, s[40:43], s50 offen sc1
  buffer_store_dwordx4 v[108:111], v6, s[40:43], s50 offen offset:1024 sc1
  s_add_u32 s53, s44, 256
  s_lshl_b32 s50, s53, 11
  v_lshl_or_b32 v112, v65, 16, v64
  v_lshl_or_b32 v113, v67, 16, v66
  v_lshl_or_b32 v114, v69, 16, v68
  v_lshl_or_b32 v115, v71, 16, v70
  v_lshl_or_b32 v116, v73, 16, v72
  v_lshl_or_b32 v117, v75, 16, v74
  v_lshl_or_b32 v118, v77, 16, v76
  v_lshl_or_b32 v119, v79, 16, v78
  buffer_store_dwordx4 v[112:115], v6, s[40:43], s50 offen sc1
  buffer_store_dwordx4 v[116:119], v6, s[40:43], s50 offen offset:1024 sc1
  s_add_u32 s53, s44, 384
  s_lshl_b32 s50, s53, 11
  v_lshl_or_b32 v120, v81, 16, v80
  v_lshl_or_b32 v121, v83, 16, v82
  v_lshl_or_b32 v122, v85, 16, v84
  v_lshl_or_b32 v123, v87, 16, v86
  v_lshl_or_b32 v124, v89, 16, v88
  v_lshl_or_b32 v125, v91, 16, v90
  v_lshl_or_b32 v126, v93, 16, v92
  v_lshl_or_b32 v127, v95, 16, v94
  buffer_store_dwordx4 v[120:123], v6, s[40:43], s50 offen sc1
  buffer_store_dwordx4 v[124:127], v6, s[40:43], s50 offen offset:1024 sc1
  s_add_u32 s44, s44, 512
  s_cmp_lt_u32 s44, 800
  s_cbranch_scc1 L_qkv_kernel_wotl
  s_endpgm
L_qkv_kernel_compute:
  v_and_b32 v2, 31, v0
  v_lshrrev_b32 v3, 5, v0
  v_bfe_u32 v4, v0, 1, 3
  v_xor_b32 v4, v4, v3
  s_lshl_b32 s46, s23, 13
  v_lshl_add_u32 v5, v2, 7, s46
  v_xor_b32 v6, 0, v4
  v_lshl_add_u32 v32, v6, 4, v5
  v_xor_b32 v6, 2, v4
  v_lshl_add_u32 v33, v6, 4, v5
  v_xor_b32 v6, 4, v4
  v_lshl_add_u32 v34, v6, 4, v5
  v_xor_b32 v6, 6, v4
  v_lshl_add_u32 v35, v6, 4, v5
  v_bfe_u32 v6, v0, 2, 2
  v_and_b32 v7, 3, v0
  v_bfe_u32 v8, v0, 4, 1
  v_lshl_add_u32 v9, v3, 3, v6
  v_lshlrev_b32 v9, 8, v9
  v_lshl_add_u32 v9, v8, 5, v9
  v_lshl_add_u32 v9, v7, 3, v9
  v_add_u32 v9, 32768, v9
  v_xor_b32 v10, 0, v6
  v_lshl_add_u32 v36, v10, 6, v9
  v_xor_b32 v10, 1, v6
  v_lshl_add_u32 v37, v10, 6, v9
  v_xor_b32 v10, 2, v6
  v_lshl_add_u32 v38, v10, 6, v9
  v_xor_b32 v10, 3, v6
  v_lshl_add_u32 v39, v10, 6, v9
  v_mov_b32 v40, v32
  v_mov_b32 v41, v33
  v_mov_b32 v42, v34
  v_mov_b32 v43, v35
  v_mov_b32 v44, v36
  v_mov_b32 v45, v37
  v_mov_b32 v46, v38
  v_mov_b32 v47, v39
  v_pk_mov_b32 v[128:129], 0, 0
  v_pk_mov_b32 v[130:131], 0, 0
  v_pk_mov_b32 v[132:133], 0, 0
  v_pk_mov_b32 v[134:135], 0, 0
  v_pk_mov_b32 v[136:137], 0, 0
  v_pk_mov_b32 v[138:139], 0, 0
  v_pk_mov_b32 v[140:141], 0, 0
  v_pk_mov_b32 v[142:143], 0, 0
  v_pk_mov_b32 v[144:145], 0, 0
  v_pk_mov_b32 v[146:147], 0, 0
  v_pk_mov_b32 v[148:149], 0, 0
  v_pk_mov_b32 v[150:151], 0, 0
  v_pk_mov_b32 v[152:153], 0, 0
  v_pk_mov_b32 v[154:155], 0, 0
  v_pk_mov_b32 v[156:157], 0, 0
  v_pk_mov_b32 v[158:159], 0, 0
  v_pk_mov_b32 v[160:161], 0, 0
  v_pk_mov_b32 v[162:163], 0, 0
  v_pk_mov_b32 v[164:165], 0, 0
  v_pk_mov_b32 v[166:167], 0, 0
  v_pk_mov_b32 v[168:169], 0, 0
  v_pk_mov_b32 v[170:171], 0, 0
  v_pk_mov_b32 v[172:173], 0, 0
  v_pk_mov_b32 v[174:175], 0, 0
  v_pk_mov_b32 v[176:177], 0, 0
  v_pk_mov_b32 v[178:179], 0, 0
  v_pk_mov_b32 v[180:181], 0, 0
  v_pk_mov_b32 v[182:183], 0, 0
  v_pk_mov_b32 v[184:185], 0, 0
  v_pk_mov_b32 v[186:187], 0, 0
  v_pk_mov_b32 v[188:189], 0, 0
  v_pk_mov_b32 v[190:191], 0, 0
  v_pk_mov_b32 v[192:193], 0, 0
  v_pk_mov_b32 v[194:195], 0, 0
  v_pk_mov_b32 v[196:197], 0, 0
  v_pk_mov_b32 v[198:199], 0, 0
  v_pk_mov_b32 v[200:201], 0, 0
  v_pk_mov_b32 v[202:203], 0, 0
  v_pk_mov_b32 v[204:205], 0, 0
  v_pk_mov_b32 v[206:207], 0, 0
  v_pk_mov_b32 v[208:209], 0, 0
  v_pk_mov_b32 v[210:211], 0, 0
  v_pk_mov_b32 v[212:213], 0, 0
  v_pk_mov_b32 v[214:215], 0, 0
  v_pk_mov_b32 v[216:217], 0, 0
  v_pk_mov_b32 v[218:219], 0, 0
  v_pk_mov_b32 v[220:221], 0, 0
  v_pk_mov_b32 v[222:223], 0, 0
  v_pk_mov_b32 v[224:225], 0, 0
  v_pk_mov_b32 v[226:227], 0, 0
  v_pk_mov_b32 v[228:229], 0, 0
  v_pk_mov_b32 v[230:231], 0, 0
  v_pk_mov_b32 v[232:233], 0, 0
  v_pk_mov_b32 v[234:235], 0, 0
  v_pk_mov_b32 v[236:237], 0, 0
  v_pk_mov_b32 v[238:239], 0, 0
  v_pk_mov_b32 v[240:241], 0, 0
  v_pk_mov_b32 v[242:243], 0, 0
  v_pk_mov_b32 v[244:245], 0, 0
  v_pk_mov_b32 v[246:247], 0, 0
  v_pk_mov_b32 v[248:249], 0, 0
  v_pk_mov_b32 v[250:251], 0, 0
  v_pk_mov_b32 v[252:253], 0, 0
  v_pk_mov_b32 v[254:255], 0, 0
  s_waitcnt lgkmcnt(0)
  s_mov_b32 s48, 0
  s_mov_b32 s49, 0
  s_lshl_b32 s51, s21, 3
  s_lshl_b32 s52, s23, 1
  s_add_u32 s51, s51, s52
  s_mul_i32 s50, s20, 7864320
  s_cmp_lt_u32 s22, 10
  s_cbranch_scc0 L_qkv_kernel_c1
  v_lshrrev_b32 v4, 1, v2
  v_xor_b32 v4, v4, v2
  v_and_b32 v4, 4, v4
  s_cmp_lt_u32 s22, 5
  s_cselect_b32 s52, 0, 3
  s_cselect_b32 s53, 0, 5
  s_cselect_b32 s54, 1280, 0
  s_cselect_b32 s55, 163840, 0
  v_mul_u32_u24 v4, s52, v4
  v_xor_b32 v4, v4, v2
  v_lshlrev_b32 v4, 3, v4
  s_sub_u32 s53, s22, s53
  s_lshl_b32 s53, s53, 5
  v_add_u32 v5, s53, v3
  v_add_u32 v6, 0, v5
  v_mul_u32_u24 v7, 205, v6
  v_lshrrev_b32 v7, 10, v7
  v_mul_u32_u24 v7, 244480, v7
  v_lshl_add_u32 v6, v6, 8, v4
  v_add_u32 v16, v6, v7
  v_add_u32 v6, 2, v5
  v_mul_u32_u24 v7, 205, v6
  v_lshrrev_b32 v7, 10, v7
  v_mul_u32_u24 v7, 244480, v7
  v_lshl_add_u32 v6, v6, 8, v4
  v_add_u32 v17, v6, v7
  v_add_u32 v6, 4, v5
  v_mul_u32_u24 v7, 205, v6
  v_lshrrev_b32 v7, 10, v7
  v_mul_u32_u24 v7, 244480, v7
  v_lshl_add_u32 v6, v6, 8, v4
  v_add_u32 v18, v6, v7
  v_add_u32 v6, 6, v5
  v_mul_u32_u24 v7, 205, v6
  v_lshrrev_b32 v7, 10, v7
  v_mul_u32_u24 v7, 244480, v7
  v_lshl_add_u32 v6, v6, 8, v4
  v_add_u32 v19, v6, v7
  v_add_u32 v6, 8, v5
  v_mul_u32_u24 v7, 205, v6
  v_lshrrev_b32 v7, 10, v7
  v_mul_u32_u24 v7, 244480, v7
  v_lshl_add_u32 v6, v6, 8, v4
  v_add_u32 v20, v6, v7
  v_add_u32 v6, 10, v5
  v_mul_u32_u24 v7, 205, v6
  v_lshrrev_b32 v7, 10, v7
  v_mul_u32_u24 v7, 244480, v7
  v_lshl_add_u32 v6, v6, 8, v4
  v_add_u32 v21, v6, v7
  v_add_u32 v6, 12, v5
  v_mul_u32_u24 v7, 205, v6
  v_lshrrev_b32 v7, 10, v7
  v_mul_u32_u24 v7, 244480, v7
  v_lshl_add_u32 v6, v6, 8, v4
  v_add_u32 v22, v6, v7
  v_add_u32 v6, 14, v5
  v_mul_u32_u24 v7, 205, v6
  v_lshrrev_b32 v7, 10, v7
  v_mul_u32_u24 v7, 244480, v7
  v_lshl_add_u32 v6, v6, 8, v4
  v_add_u32 v23, v6, v7
  v_add_u32 v6, 16, v5
  v_mul_u32_u24 v7, 205, v6
  v_lshrrev_b32 v7, 10, v7
  v_mul_u32_u24 v7, 244480, v7
  v_lshl_add_u32 v6, v6, 8, v4
  v_add_u32 v24, v6, v7
  v_add_u32 v6, 18, v5
  v_mul_u32_u24 v7, 205, v6
  v_lshrrev_b32 v7, 10, v7
  v_mul_u32_u24 v7, 244480, v7
  v_lshl_add_u32 v6, v6, 8, v4
  v_add_u32 v25, v6, v7
  v_add_u32 v6, 20, v5
  v_mul_u32_u24 v7, 205, v6
  v_lshrrev_b32 v7, 10, v7
  v_mul_u32_u24 v7, 244480, v7
  v_lshl_add_u32 v6, v6, 8, v4
  v_add_u32 v26, v6, v7
  v_add_u32 v6, 22, v5
  v_mul_u32_u24 v7, 205, v6
  v_lshrrev_b32 v7, 10, v7
  v_mul_u32_u24 v7, 244480, v7
  v_lshl_add_u32 v6, v6, 8, v4
  v_add_u32 v27, v6, v7
  v_add_u32 v6, 24, v5
  v_mul_u32_u24 v7, 205, v6
  v_lshrrev_b32 v7, 10, v7
  v_mul_u32_u24 v7, 244480, v7
  v_lshl_add_u32 v6, v6, 8, v4
  v_add_u32 v28, v6, v7
  v_add_u32 v6, 26, v5
  v_mul_u32_u24 v7, 205, v6
  v_lshrrev_b32 v7, 10, v7
  v_mul_u32_u24 v7, 244480, v7
  v_lshl_add_u32 v6, v6, 8, v4
  v_add_u32 v29, v6, v7
  v_add_u32 v6, 28, v5
  v_mul_u32_u24 v7, 205, v6
  v_lshrrev_b32 v7, 10, v7
  v_mul_u32_u24 v7, 244480, v7
  v_lshl_add_u32 v6, v6, 8, v4
  v_add_u32 v30, v6, v7
  v_add_u32 v6, 30, v5
  v_mul_u32_u24 v7, 205, v6
  v_lshrrev_b32 v7, 10, v7
  v_mul_u32_u24 v7, 244480, v7
  v_lshl_add_u32 v6, v6, 8, v4
  v_add_u32 v31, v6, v7
  s_sub_u32 s54, 2560, s54
  s_add_u32 s50, s50, s55
  s_mul_i32 s55, s51, s54
  s_add_u32 s50, s50, s55
  s_add_u32 s55, s50, s54
  s_barrier
  ds_read_b128 v[64:67], v40
  ds_read_b64_tr_b16 v[72:73], v44 offset:0
  ds_read_b64_tr_b16 v[74:75], v44 offset:1024
  ds_read_b128 v[68:71], v40 offset:4096
  ds_read_b64_tr_b16 v[76:77], v45 offset:0
  ds_read_b64_tr_b16 v[78:79], v45 offset:1024
  ds_read_b64_tr_b16 v[80:81], v46 offset:0
  ds_read_b64_tr_b16 v[82:83], v46 offset:1024
  ds_read_b64_tr_b16 v[84:85], v47 offset:0
  ds_read_b64_tr_b16 v[86:87], v47 offset:1024
.p2align 6
L_qkv_kernel_loop0:
  s_waitcnt lgkmcnt(7)
  v_mfma_f32_32x32x16_bf16 v[128:143], v[72:75], v[64:67], v[128:143]
  ds_read_b128 v[88:91], v41
  ds_read_b64_tr_b16 v[96:97], v44 offset:4096
  s_waitcnt lgkmcnt(8)
  v_mfma_f32_32x32x16_bf16 v[192:207], v[72:75], v[68:71], v[192:207]
  ds_read_b64_tr_b16 v[98:99], v44 offset:5120
  ds_read_b128 v[92:95], v41 offset:4096
  s_waitcnt lgkmcnt(8)
  v_mfma_f32_32x32x16_bf16 v[144:159], v[76:79], v[64:67], v[144:159]
  ds_read_b64_tr_b16 v[100:101], v45 offset:4096
  ds_read_b64_tr_b16 v[102:103], v45 offset:5120
  v_mfma_f32_32x32x16_bf16 v[208:223], v[76:79], v[68:71], v[208:223]
  ds_read_b64_tr_b16 v[104:105], v46 offset:4096
  ds_read_b64_tr_b16 v[106:107], v46 offset:5120
  s_waitcnt lgkmcnt(10)
  v_mfma_f32_32x32x16_bf16 v[160:175], v[80:83], v[64:67], v[160:175]
  ds_read_b64_tr_b16 v[108:109], v47 offset:4096
  ds_read_b64_tr_b16 v[110:111], v47 offset:5120
  v_mfma_f32_32x32x16_bf16 v[224:239], v[80:83], v[68:71], v[224:239]
  s_waitcnt lgkmcnt(10)
  v_mfma_f32_32x32x16_bf16 v[176:191], v[84:87], v[64:67], v[176:191]
  v_mfma_f32_32x32x16_bf16 v[240:255], v[84:87], v[68:71], v[240:255]
  s_waitcnt lgkmcnt(7)
  v_mfma_f32_32x32x16_bf16 v[128:143], v[96:99], v[88:91], v[128:143]
  ds_read_b128 v[64:67], v42
  ds_read_b64_tr_b16 v[72:73], v44 offset:8192
  s_waitcnt lgkmcnt(8)
  v_mfma_f32_32x32x16_bf16 v[192:207], v[96:99], v[92:95], v[192:207]
  ds_read_b64_tr_b16 v[74:75], v44 offset:9216
  ds_read_b128 v[68:71], v42 offset:4096
  s_waitcnt lgkmcnt(8)
  v_mfma_f32_32x32x16_bf16 v[144:159], v[100:103], v[88:91], v[144:159]
  ds_read_b64_tr_b16 v[76:77], v45 offset:8192
  ds_read_b64_tr_b16 v[78:79], v45 offset:9216
  v_mfma_f32_32x32x16_bf16 v[208:223], v[100:103], v[92:95], v[208:223]
  ds_read_b64_tr_b16 v[80:81], v46 offset:8192
  ds_read_b64_tr_b16 v[82:83], v46 offset:9216
  s_waitcnt lgkmcnt(10)
  v_mfma_f32_32x32x16_bf16 v[160:175], v[104:107], v[88:91], v[160:175]
  ds_read_b64_tr_b16 v[84:85], v47 offset:8192
  ds_read_b64_tr_b16 v[86:87], v47 offset:9216
  v_mfma_f32_32x32x16_bf16 v[224:239], v[104:107], v[92:95], v[224:239]
  s_waitcnt lgkmcnt(10)
  v_mfma_f32_32x32x16_bf16 v[176:191], v[108:111], v[88:91], v[176:191]
  v_mfma_f32_32x32x16_bf16 v[240:255], v[108:111], v[92:95], v[240:255]
  s_waitcnt lgkmcnt(7)
  v_mfma_f32_32x32x16_bf16 v[128:143], v[72:75], v[64:67], v[128:143]
  ds_read_b128 v[88:91], v43
  ds_read_b64_tr_b16 v[96:97], v44 offset:12288
  s_waitcnt lgkmcnt(8)
  v_mfma_f32_32x32x16_bf16 v[192:207], v[72:75], v[68:71], v[192:207]
  ds_read_b64_tr_b16 v[98:99], v44 offset:13312
  ds_read_b128 v[92:95], v43 offset:4096
  s_waitcnt lgkmcnt(8)
  v_mfma_f32_32x32x16_bf16 v[144:159], v[76:79], v[64:67], v[144:159]
  ds_read_b64_tr_b16 v[100:101], v45 offset:12288
  ds_read_b64_tr_b16 v[102:103], v45 offset:13312
  v_mfma_f32_32x32x16_bf16 v[208:223], v[76:79], v[68:71], v[208:223]
  ds_read_b64_tr_b16 v[104:105], v46 offset:12288
  ds_read_b64_tr_b16 v[106:107], v46 offset:13312
  s_add_u32 s48, s48, 49152
  s_cmp_eq_u32 s48, 147456
  s_cselect_b32 s48, 0, s48
  s_add_u32 s49, s49, 1
  s_cmp_eq_u32 s49, 9
  s_waitcnt lgkmcnt(10)
  v_mfma_f32_32x32x16_bf16 v[160:175], v[80:83], v[64:67], v[160:175]
  ds_read_b64_tr_b16 v[108:109], v47 offset:12288
  ds_read_b64_tr_b16 v[110:111], v47 offset:13312
  v_mfma_f32_32x32x16_bf16 v[224:239], v[80:83], v[68:71], v[224:239]
  v_add_u32 v40, s48, v32
  v_add_u32 v41, s48, v33
  v_add_u32 v42, s48, v34
  s_waitcnt lgkmcnt(10)
  v_mfma_f32_32x32x16_bf16 v[176:191], v[84:87], v[64:67], v[176:191]
  v_add_u32 v43, s48, v35
  v_add_u32 v44, s48, v36
  v_add_u32 v45, s48, v37
  v_mfma_f32_32x32x16_bf16 v[240:255], v[84:87], v[68:71], v[240:255]
  v_add_u32 v46, s48, v38
  v_add_u32 v47, s48, v39
  s_waitcnt lgkmcnt(7)
  v_mfma_f32_32x32x16_bf16 v[128:143], v[96:99], v[88:91], v[128:143]
  s_waitcnt lgkmcnt(6)
  v_mfma_f32_32x32x16_bf16 v[192:207], v[96:99], v[92:95], v[192:207]
  s_waitcnt lgkmcnt(0)
  s_barrier
  s_cbranch_scc1 L_qkv_kernel_last0
  v_mfma_f32_32x32x16_bf16 v[144:159], v[100:103], v[88:91], v[144:159]
  ds_read_b128 v[64:67], v40
  ds_read_b64_tr_b16 v[72:73], v44 offset:0
  v_mfma_f32_32x32x16_bf16 v[208:223], v[100:103], v[92:95], v[208:223]
  ds_read_b64_tr_b16 v[74:75], v44 offset:1024
  ds_read_b128 v[68:71], v40 offset:4096
  v_mfma_f32_32x32x16_bf16 v[160:175], v[104:107], v[88:91], v[160:175]
  ds_read_b64_tr_b16 v[76:77], v45 offset:0
  ds_read_b64_tr_b16 v[78:79], v45 offset:1024
  v_mfma_f32_32x32x16_bf16 v[224:239], v[104:107], v[92:95], v[224:239]
  ds_read_b64_tr_b16 v[80:81], v46 offset:0
  ds_read_b64_tr_b16 v[82:83], v46 offset:1024
  v_mfma_f32_32x32x16_bf16 v[176:191], v[108:111], v[88:91], v[176:191]
  ds_read_b64_tr_b16 v[84:85], v47 offset:0
  ds_read_b64_tr_b16 v[86:87], v47 offset:1024
  v_mfma_f32_32x32x16_bf16 v[240:255], v[108:111], v[92:95], v[240:255]
  s_branch L_qkv_kernel_loop0
L_qkv_kernel_last0:
  v_mfma_f32_32x32x16_bf16 v[144:159], v[100:103], v[88:91], v[144:159]
  ds_read_b128 v[64:67], v40 offset:0
  ds_read_b64_tr_b16 v[120:121], v44 offset:0
  ds_read_b128 v[80:83], v40 offset:4096
  v_mfma_f32_32x32x16_bf16 v[208:223], v[100:103], v[92:95], v[208:223]
  ds_read_b64_tr_b16 v[122:123], v44 offset:1024
  ds_read_b128 v[68:71], v41 offset:0
  ds_read_b64_tr_b16 v[124:125], v44 offset:4096
  v_mfma_f32_32x32x16_bf16 v[160:175], v[104:107], v[88:91], v[160:175]
  ds_read_b128 v[84:87], v41 offset:4096
  ds_read_b64_tr_b16 v[126:127], v44 offset:5120
  ds_read_b128 v[72:75], v42 offset:0
  v_mfma_f32_32x32x16_bf16 v[224:239], v[104:107], v[92:95], v[224:239]
  ds_read_b64_tr_b16 v[52:53], v44 offset:8192
  ds_read_b128 v[112:115], v42 offset:4096
  ds_read_b64_tr_b16 v[54:55], v44 offset:9216
  v_mfma_f32_32x32x16_bf16 v[176:191], v[108:111], v[88:91], v[176:191]
  ds_read_b128 v[76:79], v43 offset:0
  ds_read_b64_tr_b16 v[56:57], v44 offset:12288
  ds_read_b128 v[116:119], v43 offset:4096
  v_mfma_f32_32x32x16_bf16 v[240:255], v[108:111], v[92:95], v[240:255]
  ds_read_b64_tr_b16 v[58:59], v44 offset:13312
  s_mov_b32 s32, s16
  s_mov_b32 s33, s17
  s_mov_b32 s34, 0xf00000
  s_mov_b32 s35, 0x20000
  s_mov_b32 s52, 0x3ea52b5c
  s_mov_b32 s53, 0x3ea52b5c
  s_cmp_lt_u32 s22, 5
  s_cbranch_scc0 L_qkv_kernel_konly
  s_waitcnt lgkmcnt(0)
  v_mfma_f32_32x32x16_bf16 v[128:143], v[120:123], v[64:67], v[128:143]
  ds_read_b64_tr_b16 v[88:89], v45 offset:0
  ds_read_b64_tr_b16 v[90:91], v45 offset:1024
  ds_read_b64_tr_b16 v[92:93], v45 offset:4096
  v_mfma_f32_32x32x16_bf16 v[192:207], v[120:123], v[80:83], v[192:207]
  ds_read_b64_tr_b16 v[94:95], v45 offset:5120
  ds_read_b64_tr_b16 v[96:97], v45 offset:8192
  ds_read_b64_tr_b16 v[98:99], v45 offset:9216
  v_mfma_f32_32x32x16_bf16 v[128:143], v[124:127], v[68:71], v[128:143]
  ds_read_b64_tr_b16 v[100:101], v45 offset:12288
  ds_read_b64_tr_b16 v[102:103], v45 offset:13312
  v_mfma_f32_32x32x16_bf16 v[192:207], v[124:127], v[84:87], v[192:207]
  v_mfma_f32_32x32x16_bf16 v[128:143], v[52:55], v[72:75], v[128:143]
  v_mfma_f32_32x32x16_bf16 v[192:207], v[52:55], v[112:115], v[192:207]
  v_mfma_f32_32x32x16_bf16 v[128:143], v[56:59], v[76:79], v[128:143]
  v_mfma_f32_32x32x16_bf16 v[192:207], v[56:59], v[116:119], v[192:207]
  s_waitcnt lgkmcnt(0)
  v_mfma_f32_32x32x16_bf16 v[144:159], v[88:91], v[64:67], v[144:159]
  ds_read_b64_tr_b16 v[120:121], v46 offset:0
  ds_read_b64_tr_b16 v[122:123], v46 offset:1024
  ds_read_b64_tr_b16 v[124:125], v46 offset:4096
  v_mfma_f32_32x32x16_bf16 v[208:223], v[88:91], v[80:83], v[208:223]
  ds_read_b64_tr_b16 v[126:127], v46 offset:5120
  ds_read_b64_tr_b16 v[52:53], v46 offset:8192
  ds_read_b64_tr_b16 v[54:55], v46 offset:9216
  v_mfma_f32_32x32x16_bf16 v[144:159], v[92:95], v[68:71], v[144:159]
  ds_read_b64_tr_b16 v[56:57], v46 offset:12288
  ds_read_b64_tr_b16 v[58:59], v46 offset:13312
  v_mfma_f32_32x32x16_bf16 v[208:223], v[92:95], v[84:87], v[208:223]
  v_pk_mul_f32 v[128:129], s[52:53], v[128:129]
  v_pk_mul_f32 v[130:131], s[52:53], v[130:131]
  v_pk_mul_f32 v[132:133], s[52:53], v[132:133]
  v_pk_mul_f32 v[134:135], s[52:53], v[134:135]
  v_pk_mul_f32 v[136:137], s[52:53], v[136:137]
  v_pk_mul_f32 v[138:139], s[52:53], v[138:139]
  v_pk_mul_f32 v[140:141], s[52:53], v[140:141]
  v_pk_mul_f32 v[142:143], s[52:53], v[142:143]
  v_mfma_f32_32x32x16_bf16 v[144:159], v[96:99], v[72:75], v[144:159]
  v_cvt_pk_bf16_f32 v128, v128, v129
  v_cvt_pk_bf16_f32 v129, v130, v131
  v_cvt_pk_bf16_f32 v130, v132, v133
  v_cvt_pk_bf16_f32 v131, v134, v135
  v_cvt_pk_bf16_f32 v132, v136, v137
  v_cvt_pk_bf16_f32 v133, v138, v139
  v_cvt_pk_bf16_f32 v134, v140, v141
  v_cvt_pk_bf16_f32 v135, v142, v143
  v_mfma_f32_32x32x16_bf16 v[208:223], v[96:99], v[112:115], v[208:223]
  buffer_store_dwordx2 v[128:129], v16, s[32:35], s50 offen sc1
  buffer_store_dwordx2 v[130:131], v17, s[32:35], s50 offen sc1
  buffer_store_dwordx2 v[132:133], v18, s[32:35], s50 offen sc1
  buffer_store_dwordx2 v[134:135], v19, s[32:35], s50 offen sc1
  v_pk_mul_f32 v[192:193], s[52:53], v[192:193]
  v_pk_mul_f32 v[194:195], s[52:53], v[194:195]
  v_pk_mul_f32 v[196:197], s[52:53], v[196:197]
  v_pk_mul_f32 v[198:199], s[52:53], v[198:199]
  v_mfma_f32_32x32x16_bf16 v[144:159], v[100:103], v[76:79], v[144:159]
  v_pk_mul_f32 v[200:201], s[52:53], v[200:201]
  v_pk_mul_f32 v[202:203], s[52:53], v[202:203]
  v_pk_mul_f32 v[204:205], s[52:53], v[204:205]
  v_pk_mul_f32 v[206:207], s[52:53], v[206:207]
  v_cvt_pk_bf16_f32 v192, v192, v193
  v_cvt_pk_bf16_f32 v193, v194, v195
  v_cvt_pk_bf16_f32 v194, v196, v197
  v_cvt_pk_bf16_f32 v195, v198, v199
  v_mfma_f32_32x32x16_bf16 v[208:223], v[100:103], v[116:119], v[208:223]
  v_cvt_pk_bf16_f32 v196, v200, v201
  v_cvt_pk_bf16_f32 v197, v202, v203
  v_cvt_pk_bf16_f32 v198, v204, v205
  v_cvt_pk_bf16_f32 v199, v206, v207
  buffer_store_dwordx2 v[192:193], v16, s[32:35], s55 offen sc1
  buffer_store_dwordx2 v[194:195], v17, s[32:35], s55 offen sc1
  buffer_store_dwordx2 v[196:197], v18, s[32:35], s55 offen sc1
  buffer_store_dwordx2 v[198:199], v19, s[32:35], s55 offen sc1
  s_waitcnt lgkmcnt(0)
  v_mfma_f32_32x32x16_bf16 v[160:175], v[120:123], v[64:67], v[160:175]
  ds_read_b64_tr_b16 v[88:89], v47 offset:0
  ds_read_b64_tr_b16 v[90:91], v47 offset:1024
  ds_read_b64_tr_b16 v[92:93], v47 offset:4096
  v_mfma_f32_32x32x16_bf16 v[224:239], v[120:123], v[80:83], v[224:239]
  ds_read_b64_tr_b16 v[94:95], v47 offset:5120
  ds_read_b64_tr_b16 v[96:97], v47 offset:8192
  ds_read_b64_tr_b16 v[98:99], v47 offset:9216
  v_mfma_f32_32x32x16_bf16 v[160:175], v[124:127], v[68:71], v[160:175]
  ds_read_b64_tr_b16 v[100:101], v47 offset:12288
  ds_read_b64_tr_b16 v[102:103], v47 offset:13312
  v_mfma_f32_32x32x16_bf16 v[224:239], v[124:127], v[84:87], v[224:239]
  v_pk_mul_f32 v[144:145], s[52:53], v[144:145]
  v_pk_mul_f32 v[146:147], s[52:53], v[146:147]
  v_pk_mul_f32 v[148:149], s[52:53], v[148:149]
  v_pk_mul_f32 v[150:151], s[52:53], v[150:151]
  v_pk_mul_f32 v[152:153], s[52:53], v[152:153]
  v_pk_mul_f32 v[154:155], s[52:53], v[154:155]
  v_pk_mul_f32 v[156:157], s[52:53], v[156:157]
  v_pk_mul_f32 v[158:159], s[52:53], v[158:159]
  v_mfma_f32_32x32x16_bf16 v[160:175], v[52:55], v[72:75], v[160:175]
  v_cvt_pk_bf16_f32 v144, v144, v145
  v_cvt_pk_bf16_f32 v145, v146, v147
  v_cvt_pk_bf16_f32 v146, v148, v149
  v_cvt_pk_bf16_f32 v147, v150, v151
  v_cvt_pk_bf16_f32 v148, v152, v153
  v_cvt_pk_bf16_f32 v149, v154, v155
  v_cvt_pk_bf16_f32 v150, v156, v157
  v_cvt_pk_bf16_f32 v151, v158, v159
  v_mfma_f32_32x32x16_bf16 v[224:239], v[52:55], v[112:115], v[224:239]
  buffer_store_dwordx2 v[144:145], v20, s[32:35], s50 offen sc1
  buffer_store_dwordx2 v[146:147], v21, s[32:35], s50 offen sc1
  buffer_store_dwordx2 v[148:149], v22, s[32:35], s50 offen sc1
  buffer_store_dwordx2 v[150:151], v23, s[32:35], s50 offen sc1
  v_pk_mul_f32 v[208:209], s[52:53], v[208:209]
  v_pk_mul_f32 v[210:211], s[52:53], v[210:211]
  v_pk_mul_f32 v[212:213], s[52:53], v[212:213]
  v_pk_mul_f32 v[214:215], s[52:53], v[214:215]
  v_mfma_f32_32x32x16_bf16 v[160:175], v[56:59], v[76:79], v[160:175]
  v_pk_mul_f32 v[216:217], s[52:53], v[216:217]
  v_pk_mul_f32 v[218:219], s[52:53], v[218:219]
  v_pk_mul_f32 v[220:221], s[52:53], v[220:221]
  v_pk_mul_f32 v[222:223], s[52:53], v[222:223]
  v_cvt_pk_bf16_f32 v208, v208, v209
  v_cvt_pk_bf16_f32 v209, v210, v211
  v_cvt_pk_bf16_f32 v210, v212, v213
  v_cvt_pk_bf16_f32 v211, v214, v215
  v_mfma_f32_32x32x16_bf16 v[224:239], v[56:59], v[116:119], v[224:239]
  v_cvt_pk_bf16_f32 v212, v216, v217
  v_cvt_pk_bf16_f32 v213, v218, v219
  v_cvt_pk_bf16_f32 v214, v220, v221
  v_cvt_pk_bf16_f32 v215, v222, v223
  buffer_store_dwordx2 v[208:209], v20, s[32:35], s55 offen sc1
  buffer_store_dwordx2 v[210:211], v21, s[32:35], s55 offen sc1
  buffer_store_dwordx2 v[212:213], v22, s[32:35], s55 offen sc1
  buffer_store_dwordx2 v[214:215], v23, s[32:35], s55 offen sc1
  s_waitcnt lgkmcnt(0)
  v_mfma_f32_32x32x16_bf16 v[176:191], v[88:91], v[64:67], v[176:191]
  v_mfma_f32_32x32x16_bf16 v[240:255], v[88:91], v[80:83], v[240:255]
  v_mfma_f32_32x32x16_bf16 v[176:191], v[92:95], v[68:71], v[176:191]
  v_mfma_f32_32x32x16_bf16 v[240:255], v[92:95], v[84:87], v[240:255]
  s_nop 6
  v_pk_mul_f32 v[160:161], s[52:53], v[160:161]
  v_pk_mul_f32 v[162:163], s[52:53], v[162:163]
  v_pk_mul_f32 v[164:165], s[52:53], v[164:165]
  v_pk_mul_f32 v[166:167], s[52:53], v[166:167]
  v_pk_mul_f32 v[168:169], s[52:53], v[168:169]
  v_pk_mul_f32 v[170:171], s[52:53], v[170:171]
  v_pk_mul_f32 v[172:173], s[52:53], v[172:173]
  v_pk_mul_f32 v[174:175], s[52:53], v[174:175]
  v_mfma_f32_32x32x16_bf16 v[176:191], v[96:99], v[72:75], v[176:191]
  v_cvt_pk_bf16_f32 v160, v160, v161
  v_cvt_pk_bf16_f32 v161, v162, v163
  v_cvt_pk_bf16_f32 v162, v164, v165
  v_cvt_pk_bf16_f32 v163, v166, v167
  v_cvt_pk_bf16_f32 v164, v168, v169
  v_cvt_pk_bf16_f32 v165, v170, v171
  v_cvt_pk_bf16_f32 v166, v172, v173
  v_cvt_pk_bf16_f32 v167, v174, v175
  v_mfma_f32_32x32x16_bf16 v[240:255], v[96:99], v[112:115], v[240:255]
  buffer_store_dwordx2 v[160:161], v24, s[32:35], s50 offen sc1
  buffer_store_dwordx2 v[162:163], v25, s[32:35], s50 offen sc1
  buffer_store_dwordx2 v[164:165], v26, s[32:35], s50 offen sc1
  buffer_store_dwordx2 v[166:167], v27, s[32:35], s50 offen sc1
  v_pk_mul_f32 v[224:225], s[52:53], v[224:225]
  v_pk_mul_f32 v[226:227], s[52:53], v[226:227]
  v_pk_mul_f32 v[228:229], s[52:53], v[228:229]
  v_pk_mul_f32 v[230:231], s[52:53], v[230:231]
  v_mfma_f32_32x32x16_bf16 v[176:191], v[100:103], v[76:79], v[176:191]
  v_pk_mul_f32 v[232:233], s[52:53], v[232:233]
  v_pk_mul_f32 v[234:235], s[52:53], v[234:235]
  v_pk_mul_f32 v[236:237], s[52:53], v[236:237]
  v_pk_mul_f32 v[238:239], s[52:53], v[238:239]
  v_cvt_pk_bf16_f32 v224, v224, v225
  v_cvt_pk_bf16_f32 v225, v226, v227
  v_cvt_pk_bf16_f32 v226, v228, v229
  v_cvt_pk_bf16_f32 v227, v230, v231
  v_mfma_f32_32x32x16_bf16 v[240:255], v[100:103], v[116:119], v[240:255]
  v_cvt_pk_bf16_f32 v228, v232, v233
  v_cvt_pk_bf16_f32 v229, v234, v235
  v_cvt_pk_bf16_f32 v230, v236, v237
  v_cvt_pk_bf16_f32 v231, v238, v239
  buffer_store_dwordx2 v[224:225], v24, s[32:35], s55 offen sc1
  buffer_store_dwordx2 v[226:227], v25, s[32:35], s55 offen sc1
  buffer_store_dwordx2 v[228:229], v26, s[32:35], s55 offen sc1
  buffer_store_dwordx2 v[230:231], v27, s[32:35], s55 offen sc1
  s_nop 15
  v_pk_mul_f32 v[176:177], s[52:53], v[176:177]
  v_pk_mul_f32 v[178:179], s[52:53], v[178:179]
  v_pk_mul_f32 v[180:181], s[52:53], v[180:181]
  v_pk_mul_f32 v[182:183], s[52:53], v[182:183]
  v_pk_mul_f32 v[184:185], s[52:53], v[184:185]
  v_pk_mul_f32 v[186:187], s[52:53], v[186:187]
  v_pk_mul_f32 v[188:189], s[52:53], v[188:189]
  v_pk_mul_f32 v[190:191], s[52:53], v[190:191]
  v_cvt_pk_bf16_f32 v176, v176, v177
  v_cvt_pk_bf16_f32 v177, v178, v179
  v_cvt_pk_bf16_f32 v178, v180, v181
  v_cvt_pk_bf16_f32 v179, v182, v183
  v_cvt_pk_bf16_f32 v180, v184, v185
  v_cvt_pk_bf16_f32 v181, v186, v187
  v_cvt_pk_bf16_f32 v182, v188, v189
  v_cvt_pk_bf16_f32 v183, v190, v191
  buffer_store_dwordx2 v[176:177], v28, s[32:35], s50 offen sc1
  buffer_store_dwordx2 v[178:179], v29, s[32:35], s50 offen sc1
  buffer_store_dwordx2 v[180:181], v30, s[32:35], s50 offen sc1
  buffer_store_dwordx2 v[182:183], v31, s[32:35], s50 offen sc1
  v_pk_mul_f32 v[240:241], s[52:53], v[240:241]
  v_pk_mul_f32 v[242:243], s[52:53], v[242:243]
  v_pk_mul_f32 v[244:245], s[52:53], v[244:245]
  v_pk_mul_f32 v[246:247], s[52:53], v[246:247]
  v_pk_mul_f32 v[248:249], s[52:53], v[248:249]
  v_pk_mul_f32 v[250:251], s[52:53], v[250:251]
  v_pk_mul_f32 v[252:253], s[52:53], v[252:253]
  v_pk_mul_f32 v[254:255], s[52:53], v[254:255]
  v_cvt_pk_bf16_f32 v240, v240, v241
  v_cvt_pk_bf16_f32 v241, v242, v243
  v_cvt_pk_bf16_f32 v242, v244, v245
  v_cvt_pk_bf16_f32 v243, v246, v247
  v_cvt_pk_bf16_f32 v244, v248, v249
  v_cvt_pk_bf16_f32 v245, v250, v251
  v_cvt_pk_bf16_f32 v246, v252, v253
  v_cvt_pk_bf16_f32 v247, v254, v255
  buffer_store_dwordx2 v[240:241], v28, s[32:35], s55 offen sc1
  buffer_store_dwordx2 v[242:243], v29, s[32:35], s55 offen sc1
  buffer_store_dwordx2 v[244:245], v30, s[32:35], s55 offen sc1
  buffer_store_dwordx2 v[246:247], v31, s[32:35], s55 offen sc1
  s_endpgm
L_qkv_kernel_konly:
  s_waitcnt lgkmcnt(0)
  v_mfma_f32_32x32x16_bf16 v[128:143], v[120:123], v[64:67], v[128:143]
  ds_read_b64_tr_b16 v[88:89], v45 offset:0
  ds_read_b64_tr_b16 v[90:91], v45 offset:1024
  ds_read_b64_tr_b16 v[92:93], v45 offset:4096
  v_mfma_f32_32x32x16_bf16 v[192:207], v[120:123], v[80:83], v[192:207]
  ds_read_b64_tr_b16 v[94:95], v45 offset:5120
  ds_read_b64_tr_b16 v[96:97], v45 offset:8192
  ds_read_b64_tr_b16 v[98:99], v45 offset:9216
  v_mfma_f32_32x32x16_bf16 v[128:143], v[124:127], v[68:71], v[128:143]
  ds_read_b64_tr_b16 v[100:101], v45 offset:12288
  ds_read_b64_tr_b16 v[102:103], v45 offset:13312
  v_mfma_f32_32x32x16_bf16 v[192:207], v[124:127], v[84:87], v[192:207]
  v_mfma_f32_32x32x16_bf16 v[128:143], v[52:55], v[72:75], v[128:143]
  v_mfma_f32_32x32x16_bf16 v[192:207], v[52:55], v[112:115], v[192:207]
  v_mfma_f32_32x32x16_bf16 v[128:143], v[56:59], v[76:79], v[128:143]
  v_mfma_f32_32x32x16_bf16 v[192:207], v[56:59], v[116:119], v[192:207]
  s_waitcnt lgkmcnt(0)
  v_mfma_f32_32x32x16_bf16 v[144:159], v[88:91], v[64:67], v[144:159]
  ds_read_b64_tr_b16 v[120:121], v46 offset:0
  ds_read_b64_tr_b16 v[122:123], v46 offset:1024
  ds_read_b64_tr_b16 v[124:125], v46 offset:4096
  v_mfma_f32_32x32x16_bf16 v[208:223], v[88:91], v[80:83], v[208:223]
  ds_read_b64_tr_b16 v[126:127], v46 offset:5120
  ds_read_b64_tr_b16 v[52:53], v46 offset:8192
  ds_read_b64_tr_b16 v[54:55], v46 offset:9216
  v_mfma_f32_32x32x16_bf16 v[144:159], v[92:95], v[68:71], v[144:159]
  ds_read_b64_tr_b16 v[56:57], v46 offset:12288
  ds_read_b64_tr_b16 v[58:59], v46 offset:13312
  v_mfma_f32_32x32x16_bf16 v[208:223], v[92:95], v[84:87], v[208:223]
  v_cvt_pk_bf16_f32 v128, v128, v129
  v_cvt_pk_bf16_f32 v129, v130, v131
  v_cvt_pk_bf16_f32 v130, v132, v133
  v_cvt_pk_bf16_f32 v131, v134, v135
  v_cvt_pk_bf16_f32 v132, v136, v137
  v_mfma_f32_32x32x16_bf16 v[144:159], v[96:99], v[72:75], v[144:159]
  v_cvt_pk_bf16_f32 v133, v138, v139
  v_cvt_pk_bf16_f32 v134, v140, v141
  v_cvt_pk_bf16_f32 v135, v142, v143
  buffer_store_dwordx2 v[128:129], v16, s[32:35], s50 offen sc1
  buffer_store_dwordx2 v[130:131], v17, s[32:35], s50 offen sc1
  v_mfma_f32_32x32x16_bf16 v[208:223], v[96:99], v[112:115], v[208:223]
  buffer_store_dwordx2 v[132:133], v18, s[32:35], s50 offen sc1
  buffer_store_dwordx2 v[134:135], v19, s[32:35], s50 offen sc1
  v_cvt_pk_bf16_f32 v192, v192, v193
  v_cvt_pk_bf16_f32 v193, v194, v195
  v_cvt_pk_bf16_f32 v194, v196, v197
  v_mfma_f32_32x32x16_bf16 v[144:159], v[100:103], v[76:79], v[144:159]
  v_cvt_pk_bf16_f32 v195, v198, v199
  v_cvt_pk_bf16_f32 v196, v200, v201
  v_cvt_pk_bf16_f32 v197, v202, v203
  v_cvt_pk_bf16_f32 v198, v204, v205
  v_cvt_pk_bf16_f32 v199, v206, v207
  v_mfma_f32_32x32x16_bf16 v[208:223], v[100:103], v[116:119], v[208:223]
  buffer_store_dwordx2 v[192:193], v16, s[32:35], s55 offen sc1
  buffer_store_dwordx2 v[194:195], v17, s[32:35], s55 offen sc1
  buffer_store_dwordx2 v[196:197], v18, s[32:35], s55 offen sc1
  buffer_store_dwordx2 v[198:199], v19, s[32:35], s55 offen sc1
  s_waitcnt lgkmcnt(0)
  v_mfma_f32_32x32x16_bf16 v[160:175], v[120:123], v[64:67], v[160:175]
  ds_read_b64_tr_b16 v[88:89], v47 offset:0
  ds_read_b64_tr_b16 v[90:91], v47 offset:1024
  ds_read_b64_tr_b16 v[92:93], v47 offset:4096
  v_mfma_f32_32x32x16_bf16 v[224:239], v[120:123], v[80:83], v[224:239]
  ds_read_b64_tr_b16 v[94:95], v47 offset:5120
  ds_read_b64_tr_b16 v[96:97], v47 offset:8192
  ds_read_b64_tr_b16 v[98:99], v47 offset:9216
  v_mfma_f32_32x32x16_bf16 v[160:175], v[124:127], v[68:71], v[160:175]
  ds_read_b64_tr_b16 v[100:101], v47 offset:12288
  ds_read_b64_tr_b16 v[102:103], v47 offset:13312
  v_mfma_f32_32x32x16_bf16 v[224:239], v[124:127], v[84:87], v[224:239]
  v_cvt_pk_bf16_f32 v144, v144, v145
  v_cvt_pk_bf16_f32 v145, v146, v147
  v_cvt_pk_bf16_f32 v146, v148, v149
  v_cvt_pk_bf16_f32 v147, v150, v151
  v_cvt_pk_bf16_f32 v148, v152, v153
  v_mfma_f32_32x32x16_bf16 v[160:175], v[52:55], v[72:75], v[160:175]
  v_cvt_pk_bf16_f32 v149, v154, v155
  v_cvt_pk_bf16_f32 v150, v156, v157
  v_cvt_pk_bf16_f32 v151, v158, v159
  buffer_store_dwordx2 v[144:145], v20, s[32:35], s50 offen sc1
  buffer_store_dwordx2 v[146:147], v21, s[32:35], s50 offen sc1
  v_mfma_f32_32x32x16_bf16 v[224:239], v[52:55], v[112:115], v[224:239]
  buffer_store_dwordx2 v[148:149], v22, s[32:35], s50 offen sc1
  buffer_store_dwordx2 v[150:151], v23, s[32:35], s50 offen sc1
  v_cvt_pk_bf16_f32 v208, v208, v209
  v_cvt_pk_bf16_f32 v209, v210, v211
  v_cvt_pk_bf16_f32 v210, v212, v213
  v_mfma_f32_32x32x16_bf16 v[160:175], v[56:59], v[76:79], v[160:175]
  v_cvt_pk_bf16_f32 v211, v214, v215
  v_cvt_pk_bf16_f32 v212, v216, v217
  v_cvt_pk_bf16_f32 v213, v218, v219
  v_cvt_pk_bf16_f32 v214, v220, v221
  v_cvt_pk_bf16_f32 v215, v222, v223
  v_mfma_f32_32x32x16_bf16 v[224:239], v[56:59], v[116:119], v[224:239]
  buffer_store_dwordx2 v[208:209], v20, s[32:35], s55 offen sc1
  buffer_store_dwordx2 v[210:211], v21, s[32:35], s55 offen sc1
  buffer_store_dwordx2 v[212:213], v22, s[32:35], s55 offen sc1
  buffer_store_dwordx2 v[214:215], v23, s[32:35], s55 offen sc1
  s_waitcnt lgkmcnt(0)
  v_mfma_f32_32x32x16_bf16 v[176:191], v[88:91], v[64:67], v[176:191]
  v_mfma_f32_32x32x16_bf16 v[240:255], v[88:91], v[80:83], v[240:255]
  v_mfma_f32_32x32x16_bf16 v[176:191], v[92:95], v[68:71], v[176:191]
  v_mfma_f32_32x32x16_bf16 v[240:255], v[92:95], v[84:87], v[240:255]
  s_nop 6
  v_cvt_pk_bf16_f32 v160, v160, v161
  v_cvt_pk_bf16_f32 v161, v162, v163
  v_cvt_pk_bf16_f32 v162, v164, v165
  v_cvt_pk_bf16_f32 v163, v166, v167
  v_cvt_pk_bf16_f32 v164, v168, v169
  v_mfma_f32_32x32x16_bf16 v[176:191], v[96:99], v[72:75], v[176:191]
  v_cvt_pk_bf16_f32 v165, v170, v171
  v_cvt_pk_bf16_f32 v166, v172, v173
  v_cvt_pk_bf16_f32 v167, v174, v175
  buffer_store_dwordx2 v[160:161], v24, s[32:35], s50 offen sc1
  buffer_store_dwordx2 v[162:163], v25, s[32:35], s50 offen sc1
  v_mfma_f32_32x32x16_bf16 v[240:255], v[96:99], v[112:115], v[240:255]
  buffer_store_dwordx2 v[164:165], v26, s[32:35], s50 offen sc1
  buffer_store_dwordx2 v[166:167], v27, s[32:35], s50 offen sc1
  v_cvt_pk_bf16_f32 v224, v224, v225
  v_cvt_pk_bf16_f32 v225, v226, v227
  v_cvt_pk_bf16_f32 v226, v228, v229
  v_mfma_f32_32x32x16_bf16 v[176:191], v[100:103], v[76:79], v[176:191]
  v_cvt_pk_bf16_f32 v227, v230, v231
  v_cvt_pk_bf16_f32 v228, v232, v233
  v_cvt_pk_bf16_f32 v229, v234, v235
  v_cvt_pk_bf16_f32 v230, v236, v237
  v_cvt_pk_bf16_f32 v231, v238, v239
  v_mfma_f32_32x32x16_bf16 v[240:255], v[100:103], v[116:119], v[240:255]
  buffer_store_dwordx2 v[224:225], v24, s[32:35], s55 offen sc1
  buffer_store_dwordx2 v[226:227], v25, s[32:35], s55 offen sc1
  buffer_store_dwordx2 v[228:229], v26, s[32:35], s55 offen sc1
  buffer_store_dwordx2 v[230:231], v27, s[32:35], s55 offen sc1
  s_nop 15
  v_cvt_pk_bf16_f32 v176, v176, v177
  v_cvt_pk_bf16_f32 v177, v178, v179
  v_cvt_pk_bf16_f32 v178, v180, v181
  v_cvt_pk_bf16_f32 v179, v182, v183
  v_cvt_pk_bf16_f32 v180, v184, v185
  v_cvt_pk_bf16_f32 v181, v186, v187
  v_cvt_pk_bf16_f32 v182, v188, v189
  v_cvt_pk_bf16_f32 v183, v190, v191
  buffer_store_dwordx2 v[176:177], v28, s[32:35], s50 offen sc1
  buffer_store_dwordx2 v[178:179], v29, s[32:35], s50 offen sc1
  buffer_store_dwordx2 v[180:181], v30, s[32:35], s50 offen sc1
  buffer_store_dwordx2 v[182:183], v31, s[32:35], s50 offen sc1
  v_cvt_pk_bf16_f32 v240, v240, v241
  v_cvt_pk_bf16_f32 v241, v242, v243
  v_cvt_pk_bf16_f32 v242, v244, v245
  v_cvt_pk_bf16_f32 v243, v246, v247
  v_cvt_pk_bf16_f32 v244, v248, v249
  v_cvt_pk_bf16_f32 v245, v250, v251
  v_cvt_pk_bf16_f32 v246, v252, v253
  v_cvt_pk_bf16_f32 v247, v254, v255
  buffer_store_dwordx2 v[240:241], v28, s[32:35], s55 offen sc1
  buffer_store_dwordx2 v[242:243], v29, s[32:35], s55 offen sc1
  buffer_store_dwordx2 v[244:245], v30, s[32:35], s55 offen sc1
  buffer_store_dwordx2 v[246:247], v31, s[32:35], s55 offen sc1
  s_endpgm
L_qkv_kernel_c1:
  s_sub_u32 s53, s22, 10
  s_lshl_b32 s53, s53, 7
  v_add_u32 v5, s53, v2
  v_mul_u32_u24 v4, 320, v3
  v_add_u32 v6, 0, v5
  v_mul_u32_u24 v7, 3277, v6
  v_lshrrev_b32 v7, 16, v7
  v_mul_u32_u24 v7, 245440, v7
  v_lshl_add_u32 v6, v6, 4, v4
  v_add_u32 v16, v6, v7
  v_add_u32 v6, 32, v5
  v_mul_u32_u24 v7, 3277, v6
  v_lshrrev_b32 v7, 16, v7
  v_mul_u32_u24 v7, 245440, v7
  v_lshl_add_u32 v6, v6, 4, v4
  v_add_u32 v17, v6, v7
  v_add_u32 v6, 64, v5
  v_mul_u32_u24 v7, 3277, v6
  v_lshrrev_b32 v7, 16, v7
  v_mul_u32_u24 v7, 245440, v7
  v_lshl_add_u32 v6, v6, 4, v4
  v_add_u32 v18, v6, v7
  v_add_u32 v6, 96, v5
  v_mul_u32_u24 v7, 3277, v6
  v_lshrrev_b32 v7, 16, v7
  v_mul_u32_u24 v7, 245440, v7
  v_lshl_add_u32 v6, v6, 4, v4
  v_add_u32 v19, v6, v7
  s_mul_i32 s55, s51, 2560
  s_add_u32 s50, s50, s55
  s_add_u32 s50, s50, 1280
  s_barrier
  ds_read_b128 v[64:67], v40
  ds_read_b64_tr_b16 v[72:73], v44 offset:0
  ds_read_b64_tr_b16 v[74:75], v44 offset:1024
  ds_read_b128 v[68:71], v40 offset:4096
  ds_read_b64_tr_b16 v[76:77], v45 offset:0
  ds_read_b64_tr_b16 v[78:79], v45 offset:1024
  ds_read_b64_tr_b16 v[80:81], v46 offset:0
  ds_read_b64_tr_b16 v[82:83], v46 offset:1024
  ds_read_b64_tr_b16 v[84:85], v47 offset:0
  ds_read_b64_tr_b16 v[86:87], v47 offset:1024
.p2align 6
L_qkv_kernel_loop1:
  s_waitcnt lgkmcnt(7)
  v_mfma_f32_32x32x16_bf16 v[128:143], v[64:67], v[72:75], v[128:143]
  ds_read_b128 v[88:91], v41
  ds_read_b64_tr_b16 v[96:97], v44 offset:4096
  s_waitcnt lgkmcnt(8)
  v_mfma_f32_32x32x16_bf16 v[192:207], v[68:71], v[72:75], v[192:207]
  ds_read_b64_tr_b16 v[98:99], v44 offset:5120
  ds_read_b128 v[92:95], v41 offset:4096
  s_waitcnt lgkmcnt(8)
  v_mfma_f32_32x32x16_bf16 v[144:159], v[64:67], v[76:79], v[144:159]
  ds_read_b64_tr_b16 v[100:101], v45 offset:4096
  ds_read_b64_tr_b16 v[102:103], v45 offset:5120
  v_mfma_f32_32x32x16_bf16 v[208:223], v[68:71], v[76:79], v[208:223]
  ds_read_b64_tr_b16 v[104:105], v46 offset:4096
  ds_read_b64_tr_b16 v[106:107], v46 offset:5120
  s_waitcnt lgkmcnt(10)
  v_mfma_f32_32x32x16_bf16 v[160:175], v[64:67], v[80:83], v[160:175]
  ds_read_b64_tr_b16 v[108:109], v47 offset:4096
  ds_read_b64_tr_b16 v[110:111], v47 offset:5120
  v_mfma_f32_32x32x16_bf16 v[224:239], v[68:71], v[80:83], v[224:239]
  s_waitcnt lgkmcnt(10)
  v_mfma_f32_32x32x16_bf16 v[176:191], v[64:67], v[84:87], v[176:191]
  v_mfma_f32_32x32x16_bf16 v[240:255], v[68:71], v[84:87], v[240:255]
  s_waitcnt lgkmcnt(7)
  v_mfma_f32_32x32x16_bf16 v[128:143], v[88:91], v[96:99], v[128:143]
  ds_read_b128 v[64:67], v42
  ds_read_b64_tr_b16 v[72:73], v44 offset:8192
  s_waitcnt lgkmcnt(8)
  v_mfma_f32_32x32x16_bf16 v[192:207], v[92:95], v[96:99], v[192:207]
  ds_read_b64_tr_b16 v[74:75], v44 offset:9216
  ds_read_b128 v[68:71], v42 offset:4096
  s_waitcnt lgkmcnt(8)
  v_mfma_f32_32x32x16_bf16 v[144:159], v[88:91], v[100:103], v[144:159]
  ds_read_b64_tr_b16 v[76:77], v45 offset:8192
  ds_read_b64_tr_b16 v[78:79], v45 offset:9216
  v_mfma_f32_32x32x16_bf16 v[208:223], v[92:95], v[100:103], v[208:223]
  ds_read_b64_tr_b16 v[80:81], v46 offset:8192
  ds_read_b64_tr_b16 v[82:83], v46 offset:9216
  s_waitcnt lgkmcnt(10)
  v_mfma_f32_32x32x16_bf16 v[160:175], v[88:91], v[104:107], v[160:175]
  ds_read_b64_tr_b16 v[84:85], v47 offset:8192
  ds_read_b64_tr_b16 v[86:87], v47 offset:9216
  v_mfma_f32_32x32x16_bf16 v[224:239], v[92:95], v[104:107], v[224:239]
  s_waitcnt lgkmcnt(10)
  v_mfma_f32_32x32x16_bf16 v[176:191], v[88:91], v[108:111], v[176:191]
  v_mfma_f32_32x32x16_bf16 v[240:255], v[92:95], v[108:111], v[240:255]
  s_waitcnt lgkmcnt(7)
  v_mfma_f32_32x32x16_bf16 v[128:143], v[64:67], v[72:75], v[128:143]
  ds_read_b128 v[88:91], v43
  ds_read_b64_tr_b16 v[96:97], v44 offset:12288
  s_waitcnt lgkmcnt(8)
  v_mfma_f32_32x32x16_bf16 v[192:207], v[68:71], v[72:75], v[192:207]
  ds_read_b64_tr_b16 v[98:99], v44 offset:13312
  ds_read_b128 v[92:95], v43 offset:4096
  s_waitcnt lgkmcnt(8)
  v_mfma_f32_32x32x16_bf16 v[144:159], v[64:67], v[76:79], v[144:159]
  ds_read_b64_tr_b16 v[100:101], v45 offset:12288
  ds_read_b64_tr_b16 v[102:103], v45 offset:13312
  v_mfma_f32_32x32x16_bf16 v[208:223], v[68:71], v[76:79], v[208:223]
  ds_read_b64_tr_b16 v[104:105], v46 offset:12288
  ds_read_b64_tr_b16 v[106:107], v46 offset:13312
  s_add_u32 s48, s48, 49152
  s_cmp_eq_u32 s48, 147456
  s_cselect_b32 s48, 0, s48
  s_add_u32 s49, s49, 1
  s_cmp_eq_u32 s49, 9
  s_waitcnt lgkmcnt(10)
  v_mfma_f32_32x32x16_bf16 v[160:175], v[64:67], v[80:83], v[160:175]
  ds_read_b64_tr_b16 v[108:109], v47 offset:12288
  ds_read_b64_tr_b16 v[110:111], v47 offset:13312
  v_mfma_f32_32x32x16_bf16 v[224:239], v[68:71], v[80:83], v[224:239]
  v_add_u32 v40, s48, v32
  v_add_u32 v41, s48, v33
  v_add_u32 v42, s48, v34
  s_waitcnt lgkmcnt(10)
  v_mfma_f32_32x32x16_bf16 v[176:191], v[64:67], v[84:87], v[176:191]
  v_add_u32 v43, s48, v35
  v_add_u32 v44, s48, v36
  v_add_u32 v45, s48, v37
  v_mfma_f32_32x32x16_bf16 v[240:255], v[68:71], v[84:87], v[240:255]
  v_add_u32 v46, s48, v38
  v_add_u32 v47, s48, v39
  s_waitcnt lgkmcnt(7)
  v_mfma_f32_32x32x16_bf16 v[128:143], v[88:91], v[96:99], v[128:143]
  s_waitcnt lgkmcnt(6)
  v_mfma_f32_32x32x16_bf16 v[192:207], v[92:95], v[96:99], v[192:207]
  s_waitcnt lgkmcnt(0)
  s_barrier
  s_cbranch_scc1 L_qkv_kernel_last1
  v_mfma_f32_32x32x16_bf16 v[144:159], v[88:91], v[100:103], v[144:159]
  ds_read_b128 v[64:67], v40
  ds_read_b64_tr_b16 v[72:73], v44 offset:0
  v_mfma_f32_32x32x16_bf16 v[208:223], v[92:95], v[100:103], v[208:223]
  ds_read_b64_tr_b16 v[74:75], v44 offset:1024
  ds_read_b128 v[68:71], v40 offset:4096
  v_mfma_f32_32x32x16_bf16 v[160:175], v[88:91], v[104:107], v[160:175]
  ds_read_b64_tr_b16 v[76:77], v45 offset:0
  ds_read_b64_tr_b16 v[78:79], v45 offset:1024
  v_mfma_f32_32x32x16_bf16 v[224:239], v[92:95], v[104:107], v[224:239]
  ds_read_b64_tr_b16 v[80:81], v46 offset:0
  ds_read_b64_tr_b16 v[82:83], v46 offset:1024
  v_mfma_f32_32x32x16_bf16 v[176:191], v[88:91], v[108:111], v[176:191]
  ds_read_b64_tr_b16 v[84:85], v47 offset:0
  ds_read_b64_tr_b16 v[86:87], v47 offset:1024
  v_mfma_f32_32x32x16_bf16 v[240:255], v[92:95], v[108:111], v[240:255]
  s_branch L_qkv_kernel_loop1
L_qkv_kernel_last1:
  v_mfma_f32_32x32x16_bf16 v[144:159], v[88:91], v[100:103], v[144:159]
  ds_read_b128 v[64:67], v40 offset:0
  ds_read_b64_tr_b16 v[120:121], v44 offset:0
  ds_read_b128 v[80:83], v40 offset:4096
  v_mfma_f32_32x32x16_bf16 v[208:223], v[92:95], v[100:103], v[208:223]
  ds_read_b64_tr_b16 v[122:123], v44 offset:1024
  ds_read_b128 v[68:71], v41 offset:0
  ds_read_b64_tr_b16 v[124:125], v44 offset:4096
  v_mfma_f32_32x32x16_bf16 v[160:175], v[88:91], v[104:107], v[160:175]
  ds_read_b128 v[84:87], v41 offset:4096
  ds_read_b64_tr_b16 v[126:127], v44 offset:5120
  ds_read_b128 v[72:75], v42 offset:0
  v_mfma_f32_32x32x16_bf16 v[224:239], v[92:95], v[104:107], v[224:239]
  ds_read_b64_tr_b16 v[52:53], v44 offset:8192
  ds_read_b128 v[112:115], v42 offset:4096
  ds_read_b64_tr_b16 v[54:55], v44 offset:9216
  v_mfma_f32_32x32x16_bf16 v[176:191], v[88:91], v[108:111], v[176:191]
  ds_read_b128 v[76:79], v43 offset:0
  ds_read_b64_tr_b16 v[56:57], v44 offset:12288
  ds_read_b128 v[116:119], v43 offset:4096
  v_mfma_f32_32x32x16_bf16 v[240:255], v[92:95], v[108:111], v[240:255]
  ds_read_b64_tr_b16 v[58:59], v44 offset:13312
  s_mov_b32 s32, s16
  s_mov_b32 s33, s17
  s_mov_b32 s34, 0xf00000
  s_mov_b32 s35, 0x20000
  s_waitcnt lgkmcnt(0)
  v_mfma_f32_32x32x16_bf16 v[128:143], v[64:67], v[120:123], v[128:143]
  ds_read_b64_tr_b16 v[88:89], v45 offset:0
  ds_read_b64_tr_b16 v[90:91], v45 offset:1024
  ds_read_b64_tr_b16 v[92:93], v45 offset:4096
  v_mfma_f32_32x32x16_bf16 v[192:207], v[80:83], v[120:123], v[192:207]
  ds_read_b64_tr_b16 v[94:95], v45 offset:5120
  ds_read_b64_tr_b16 v[96:97], v45 offset:8192
  ds_read_b64_tr_b16 v[98:99], v45 offset:9216
  v_mfma_f32_32x32x16_bf16 v[128:143], v[68:71], v[124:127], v[128:143]
  ds_read_b64_tr_b16 v[100:101], v45 offset:12288
  ds_read_b64_tr_b16 v[102:103], v45 offset:13312
  v_mfma_f32_32x32x16_bf16 v[192:207], v[84:87], v[124:127], v[192:207]
  v_mfma_f32_32x32x16_bf16 v[128:143], v[72:75], v[52:55], v[128:143]
  v_mfma_f32_32x32x16_bf16 v[192:207], v[112:115], v[52:55], v[192:207]
  v_mfma_f32_32x32x16_bf16 v[128:143], v[76:79], v[56:59], v[128:143]
  v_mfma_f32_32x32x16_bf16 v[192:207], v[116:119], v[56:59], v[192:207]
  s_waitcnt lgkmcnt(0)
  v_mfma_f32_32x32x16_bf16 v[144:159], v[64:67], v[88:91], v[144:159]
  ds_read_b64_tr_b16 v[120:121], v46 offset:0
  ds_read_b64_tr_b16 v[122:123], v46 offset:1024
  ds_read_b64_tr_b16 v[124:125], v46 offset:4096
  v_mfma_f32_32x32x16_bf16 v[208:223], v[80:83], v[88:91], v[208:223]
  ds_read_b64_tr_b16 v[126:127], v46 offset:5120
  ds_read_b64_tr_b16 v[52:53], v46 offset:8192
  ds_read_b64_tr_b16 v[54:55], v46 offset:9216
  v_mfma_f32_32x32x16_bf16 v[144:159], v[68:71], v[92:95], v[144:159]
  ds_read_b64_tr_b16 v[56:57], v46 offset:12288
  ds_read_b64_tr_b16 v[58:59], v46 offset:13312
  v_mfma_f32_32x32x16_bf16 v[208:223], v[84:87], v[92:95], v[208:223]
  v_cvt_pk_bf16_f32 v128, v128, v129
  v_cvt_pk_bf16_f32 v129, v130, v131
  v_cvt_pk_bf16_f32 v130, v132, v133
  v_cvt_pk_bf16_f32 v131, v134, v135
  v_mfma_f32_32x32x16_bf16 v[144:159], v[72:75], v[96:99], v[144:159]
  buffer_store_dwordx4 v[128:131], v16, s[32:35], s50 offen offset:0 sc1
  v_cvt_pk_bf16_f32 v136, v136, v137
  v_cvt_pk_bf16_f32 v137, v138, v139
  v_cvt_pk_bf16_f32 v138, v140, v141
  v_mfma_f32_32x32x16_bf16 v[208:223], v[112:115], v[96:99], v[208:223]
  v_cvt_pk_bf16_f32 v139, v142, v143
  buffer_store_dwordx4 v[136:139], v16, s[32:35], s50 offen offset:640 sc1
  v_cvt_pk_bf16_f32 v192, v192, v193
  v_cvt_pk_bf16_f32 v193, v194, v195
  v_mfma_f32_32x32x16_bf16 v[144:159], v[76:79], v[100:103], v[144:159]
  v_cvt_pk_bf16_f32 v194, v196, v197
  v_cvt_pk_bf16_f32 v195, v198, v199
  buffer_store_dwordx4 v[192:195], v16, s[32:35], s50 offen offset:2560 sc1
  v_cvt_pk_bf16_f32 v200, v200, v201
  v_mfma_f32_32x32x16_bf16 v[208:223], v[116:119], v[100:103], v[208:223]
  v_cvt_pk_bf16_f32 v201, v202, v203
  v_cvt_pk_bf16_f32 v202, v204, v205
  v_cvt_pk_bf16_f32 v203, v206, v207
  buffer_store_dwordx4 v[200:203], v16, s[32:35], s50 offen offset:3200 sc1
  s_waitcnt lgkmcnt(0)
  v_mfma_f32_32x32x16_bf16 v[160:175], v[64:67], v[120:123], v[160:175]
  ds_read_b64_tr_b16 v[88:89], v47 offset:0
  ds_read_b64_tr_b16 v[90:91], v47 offset:1024
  ds_read_b64_tr_b16 v[92:93], v47 offset:4096
  v_mfma_f32_32x32x16_bf16 v[224:239], v[80:83], v[120:123], v[224:239]
  ds_read_b64_tr_b16 v[94:95], v47 offset:5120
  ds_read_b64_tr_b16 v[96:97], v47 offset:8192
  ds_read_b64_tr_b16 v[98:99], v47 offset:9216
  v_mfma_f32_32x32x16_bf16 v[160:175], v[68:71], v[124:127], v[160:175]
  ds_read_b64_tr_b16 v[100:101], v47 offset:12288
  ds_read_b64_tr_b16 v[102:103], v47 offset:13312
  v_mfma_f32_32x32x16_bf16 v[224:239], v[84:87], v[124:127], v[224:239]
  v_cvt_pk_bf16_f32 v144, v144, v145
  v_cvt_pk_bf16_f32 v145, v146, v147
  v_cvt_pk_bf16_f32 v146, v148, v149
  v_cvt_pk_bf16_f32 v147, v150, v151
  v_mfma_f32_32x32x16_bf16 v[160:175], v[72:75], v[52:55], v[160:175]
  buffer_store_dwordx4 v[144:147], v17, s[32:35], s50 offen offset:0 sc1
  v_cvt_pk_bf16_f32 v152, v152, v153
  v_cvt_pk_bf16_f32 v153, v154, v155
  v_cvt_pk_bf16_f32 v154, v156, v157
  v_mfma_f32_32x32x16_bf16 v[224:239], v[112:115], v[52:55], v[224:239]
  v_cvt_pk_bf16_f32 v155, v158, v159
  buffer_store_dwordx4 v[152:155], v17, s[32:35], s50 offen offset:640 sc1
  v_cvt_pk_bf16_f32 v208, v208, v209
  v_cvt_pk_bf16_f32 v209, v210, v211
  v_mfma_f32_32x32x16_bf16 v[160:175], v[76:79], v[56:59], v[160:175]
  v_cvt_pk_bf16_f32 v210, v212, v213
  v_cvt_pk_bf16_f32 v211, v214, v215
  buffer_store_dwordx4 v[208:211], v17, s[32:35], s50 offen offset:2560 sc1
  v_cvt_pk_bf16_f32 v216, v216, v217
  v_mfma_f32_32x32x16_bf16 v[224:239], v[116:119], v[56:59], v[224:239]
  v_cvt_pk_bf16_f32 v217, v218, v219
  v_cvt_pk_bf16_f32 v218, v220, v221
  v_cvt_pk_bf16_f32 v219, v222, v223
  buffer_store_dwordx4 v[216:219], v17, s[32:35], s50 offen offset:3200 sc1
  s_waitcnt lgkmcnt(0)
  v_mfma_f32_32x32x16_bf16 v[176:191], v[64:67], v[88:91], v[176:191]
  v_mfma_f32_32x32x16_bf16 v[240:255], v[80:83], v[88:91], v[240:255]
  v_mfma_f32_32x32x16_bf16 v[176:191], v[68:71], v[92:95], v[176:191]
  v_mfma_f32_32x32x16_bf16 v[240:255], v[84:87], v[92:95], v[240:255]
  s_nop 6
  v_cvt_pk_bf16_f32 v160, v160, v161
  v_cvt_pk_bf16_f32 v161, v162, v163
  v_cvt_pk_bf16_f32 v162, v164, v165
  v_cvt_pk_bf16_f32 v163, v166, v167
  v_mfma_f32_32x32x16_bf16 v[176:191], v[72:75], v[96:99], v[176:191]
  buffer_store_dwordx4 v[160:163], v18, s[32:35], s50 offen offset:0 sc1
  v_cvt_pk_bf16_f32 v168, v168, v169
  v_cvt_pk_bf16_f32 v169, v170, v171
  v_cvt_pk_bf16_f32 v170, v172, v173
  v_mfma_f32_32x32x16_bf16 v[240:255], v[112:115], v[96:99], v[240:255]
  v_cvt_pk_bf16_f32 v171, v174, v175
  buffer_store_dwordx4 v[168:171], v18, s[32:35], s50 offen offset:640 sc1
  v_cvt_pk_bf16_f32 v224, v224, v225
  v_cvt_pk_bf16_f32 v225, v226, v227
  v_mfma_f32_32x32x16_bf16 v[176:191], v[76:79], v[100:103], v[176:191]
  v_cvt_pk_bf16_f32 v226, v228, v229
  v_cvt_pk_bf16_f32 v227, v230, v231
  buffer_store_dwordx4 v[224:227], v18, s[32:35], s50 offen offset:2560 sc1
  v_cvt_pk_bf16_f32 v232, v232, v233
  v_mfma_f32_32x32x16_bf16 v[240:255], v[116:119], v[100:103], v[240:255]
  v_cvt_pk_bf16_f32 v233, v234, v235
  v_cvt_pk_bf16_f32 v234, v236, v237
  v_cvt_pk_bf16_f32 v235, v238, v239
  buffer_store_dwordx4 v[232:235], v18, s[32:35], s50 offen offset:3200 sc1
  s_nop 15
  v_cvt_pk_bf16_f32 v176, v176, v177
  v_cvt_pk_bf16_f32 v177, v178, v179
  v_cvt_pk_bf16_f32 v178, v180, v181
  v_cvt_pk_bf16_f32 v179, v182, v183
  buffer_store_dwordx4 v[176:179], v19, s[32:35], s50 offen offset:0 sc1
  v_cvt_pk_bf16_f32 v184, v184, v185
  v_cvt_pk_bf16_f32 v185, v186, v187
  v_cvt_pk_bf16_f32 v186, v188, v189
  v_cvt_pk_bf16_f32 v187, v190, v191
  buffer_store_dwordx4 v[184:187], v19, s[32:35], s50 offen offset:640 sc1
  v_cvt_pk_bf16_f32 v240, v240, v241
  v_cvt_pk_bf16_f32 v241, v242, v243
  v_cvt_pk_bf16_f32 v242, v244, v245
  v_cvt_pk_bf16_f32 v243, v246, v247
  buffer_store_dwordx4 v[240:243], v19, s[32:35], s50 offen offset:2560 sc1
  v_cvt_pk_bf16_f32 v248, v248, v249
  v_cvt_pk_bf16_f32 v249, v250, v251
  v_cvt_pk_bf16_f32 v250, v252, v253
  v_cvt_pk_bf16_f32 v251, v254, v255
  buffer_store_dwordx4 v[248:251], v19, s[32:35], s50 offen offset:3200 sc1
  s_endpgm
L_qkv_kernel_end:
  s_endpgm
.globl attn_kernel
.p2align 8
.type attn_kernel,@function
attn_kernel:
  s_cmp_ge_u32 s2, 256
  s_cbranch_scc1 L_attn_kernel_end
  s_load_dwordx2 s[16:17], s[0:1], 64
  v_lshrrev_b32 v1, 6, v0
  v_and_b32 v0, 63, v0
  s_and_b32 s20, s2, 7
  v_readfirstlane_b32 s23, v1
  s_lshl_b32 s20, s20, 2
  s_lshr_b32 s18, s2, 3
  s_and_b32 s19, s18, 3
  s_add_u32 s20, s20, s19
  s_lshr_b32 s21, s18, 2
  s_mul_i32 s24, s20, 245760
  s_add_u32 s25, s24, 7864320
  s_lshl_b32 s22, s21, 3
  s_add_u32 s22, s22, s23
  v_lshlrev_b32 v51, 4, v0
  v_lshlrev_b32 v55, 3, v0
  v_and_b32 v2, 31, v0
  v_lshrrev_b32 v3, 5, v0
  v_lshlrev_b32 v6, 30, v3
  v_lshl_add_u32 v4, v2, 3, v6
  v_xor_b32 v5, 0x40000000, v4
  s_mul_i32 s26, s22, 1280
  s_add_u32 s26, s26, 163840
  s_add_u32 s27, s26, s25
  s_add_u32 s26, s26, s24
  s_mul_i32 s28, s23, 5120
  s_add_u32 s30, s24, s28
  s_add_u32 s31, s30, 4096
  s_mov_b32 m0, s28
  s_mov_b32 s34, 0xf00000
  s_mov_b32 s35, 0x20000
  s_waitcnt lgkmcnt(0)
  s_mov_b32 s32, s16
  s_mov_b32 s33, s17
  buffer_load_dwordx4 v51, s[32:35], s30 offen offset:0 lds
  buffer_load_dwordx4 v51, s[32:35], s30 offen offset:1024 lds
  buffer_load_dwordx4 v51, s[32:35], s30 offen offset:2048 lds
  buffer_load_dwordx4 v51, s[32:35], s30 offen offset:3072 lds
  s_add_u32 m0, s28, 4096
  buffer_load_dwordx2 v[16:17], v55, s[32:35], s26 offen
  buffer_load_dwordx4 v51, s[32:35], s31 offen lds
  buffer_load_dwordx2 v[18:19], v55, s[32:35], s26 offen offset:512
  buffer_load_dwordx2 v[20:21], v4, s[32:35], s26 offen offset:1024
  buffer_load_dwordx2 v[22:23], v5, s[32:35], s26 offen offset:1024
  s_add_u32 s36, s16, 0x1000000
  s_addc_u32 s37, s17, 0
  s_mov_b32 s38, 0x500000
  s_mov_b32 s39, 0x20000
  s_mul_i32 s29, s21, 20480
  s_add_u32 s29, s29, s28
  s_cmp_lt_u32 s29, 20480
  s_cselect_b32 s31, 0, 20480
  s_sub_u32 s29, s29, s31
  s_add_u32 s29, s29, s25
  s_add_u32 s30, s30, 40960
  s_add_u32 s54, s28, 40960
  v_mov_b32 v44, 0xdddd
  v_lshlrev_b32 v54, 3, v2
  v_add_u32 v54, 1024, v54
  v_mul_u32_u24 v6, 2560, v3
  v_add_u32 v52, v54, v6
  v_add_u32 v6, 12, v2
  v_lshrrev_b32 v6, 5, v6
  v_lshlrev_b32 v6, 1, v6
  v_sub_u32 v6, v2, v6
  v_mul_u32_u24 v7, 320, v3
  v_lshl_add_u32 v6, v6, 4, v7
  v_add_u32 v53, 1280, v6
  s_mov_b32 s40, 0x0033ffff
  s_mov_b32 s41, 0x0033ffff
  v_mov_b32 v6, 0
  s_mov_b32 exec_lo, 0x00440000
  s_mov_b32 exec_hi, 0x00440000
  v_mov_b32 v6, 0x3f803f80
  s_mov_b64 exec, -1
  v_pk_mov_b32 v[200:201], v[6:7], v[6:7] op_sel:[0,0]
  v_pk_mov_b32 v[202:203], v[6:7], v[6:7] op_sel:[0,0]
  v_pk_mov_b32 v[204:205], v[6:7], v[6:7] op_sel:[0,0]
  v_pk_mov_b32 v[206:207], v[6:7], v[6:7] op_sel:[0,0]
  v_pk_mov_b32 v[208:209], v[6:7], v[6:7] op_sel:[0,0]
  v_pk_mov_b32 v[210:211], v[6:7], v[6:7] op_sel:[0,0]
  v_pk_mov_b32 v[212:213], v[6:7], v[6:7] op_sel:[0,0]
  v_pk_mov_b32 v[214:215], v[6:7], v[6:7] op_sel:[0,0]
  v_pk_mov_b32 v[56:57], v[6:7], v[6:7] op_sel:[0,0]
  v_pk_mov_b32 v[58:59], v[6:7], v[6:7] op_sel:[0,0]
  v_pk_mov_b32 v[60:61], v[6:7], v[6:7] op_sel:[0,0]
  v_pk_mov_b32 v[62:63], v[6:7], v[6:7] op_sel:[0,0]
  v_pk_mov_b32 v[64:65], v[6:7], v[6:7] op_sel:[0,0]
  v_pk_mov_b32 v[66:67], v[6:7], v[6:7] op_sel:[0,0]
  v_pk_mov_b32 v[68:69], v[6:7], v[6:7] op_sel:[0,0]
  v_pk_mov_b32 v[70:71], v[6:7], v[6:7] op_sel:[0,0]
  v_pk_mov_b32 v[72:73], 0, 0
  v_pk_mov_b32 v[74:75], 0, 0
  v_pk_mov_b32 v[76:77], 0, 0
  v_pk_mov_b32 v[78:79], 0, 0
  v_pk_mov_b32 v[80:81], 0, 0
  v_pk_mov_b32 v[82:83], 0, 0
  v_pk_mov_b32 v[84:85], 0, 0
  v_pk_mov_b32 v[86:87], 0, 0
  v_mov_b32 v8, 0xff800000
  v_lshlrev_b32 v7, 3, v3
  v_sub_u32 v7, v2, v7
  v_cmp_gt_i32 vcc, 0, v7
  v_cndmask_b32 v104, 0, v8, vcc
  v_cndmask_b32 v120, v8, v72, vcc
  v_cmp_gt_i32 vcc, 1, v7
  v_cndmask_b32 v105, 0, v8, vcc
  v_cndmask_b32 v121, v8, v72, vcc
  v_cmp_gt_i32 vcc, 2, v7
  v_cndmask_b32 v106, 0, v8, vcc
  v_cndmask_b32 v122, v8, v72, vcc
  v_cmp_gt_i32 vcc, 3, v7
  v_cndmask_b32 v107, 0, v8, vcc
  v_cndmask_b32 v123, v8, v72, vcc
  v_cmp_gt_i32 vcc, 4, v7
  v_cndmask_b32 v108, 0, v8, vcc
  v_cndmask_b32 v124, v8, v72, vcc
  v_cmp_gt_i32 vcc, 5, v7
  v_cndmask_b32 v109, 0, v8, vcc
  v_cndmask_b32 v125, v8, v72, vcc
  v_cmp_gt_i32 vcc, 6, v7
  v_cndmask_b32 v110, 0, v8, vcc
  v_cndmask_b32 v126, v8, v72, vcc
  v_cmp_gt_i32 vcc, 7, v7
  v_cndmask_b32 v111, 0, v8, vcc
  v_cndmask_b32 v127, v8, v72, vcc
  v_cmp_gt_i32 vcc, 16, v7
  v_cndmask_b32 v112, 0, v8, vcc
  v_cndmask_b32 v128, v8, v72, vcc
  v_cmp_gt_i32 vcc, 17, v7
  v_cndmask_b32 v113, 0, v8, vcc
  v_cndmask_b32 v129, v8, v72, vcc
  v_cmp_gt_i32 vcc, 18, v7
  v_cndmask_b32 v114, 0, v8, vcc
  v_cndmask_b32 v130, v8, v72, vcc
  v_cmp_gt_i32 vcc, 19, v7
  v_cndmask_b32 v115, 0, v8, vcc
  v_cndmask_b32 v131, v8, v72, vcc
  v_cmp_gt_i32 vcc, 20, v7
  v_cndmask_b32 v116, 0, v8, vcc
  v_cndmask_b32 v132, v8, v72, vcc
  v_cmp_gt_i32 vcc, 21, v7
  v_cndmask_b32 v117, 0, v8, vcc
  v_cndmask_b32 v133, v8, v72, vcc
  v_cmp_gt_i32 vcc, 22, v7
  v_cndmask_b32 v118, 0, v8, vcc
  v_cndmask_b32 v134, v8, v72, vcc
  v_cmp_gt_i32 vcc, 23, v7
  v_cndmask_b32 v119, 0, v8, vcc
  v_cndmask_b32 v135, v8, v72, vcc
  s_sub_u32 s42, 8, s23
  s_cmp_eq_u32 s21, 0
  s_cselect_b32 s42, s42, 0
  s_cmp_gt_u32 s42, 0
  s_cselect_b32 s44, 0xff7f, 0
  v_pk_mov_b32 v[236:237], s[44:45], 0 op_sel:[0,0]
  s_cmp_gt_u32 s42, 1
  s_cselect_b32 s44, 0xff7f, 0
  v_pk_mov_b32 v[238:239], s[44:45], 0 op_sel:[0,0]
  s_cmp_gt_u32 s42, 2
  s_cselect_b32 s44, 0xff7f, 0
  v_pk_mov_b32 v[240:241], s[44:45], 0 op_sel:[0,0]
  s_cmp_gt_u32 s42, 3
  s_cselect_b32 s44, 0xff7f, 0
  v_pk_mov_b32 v[242:243], s[44:45], 0 op_sel:[0,0]
  s_cmp_gt_u32 s42, 4
  s_cselect_b32 s44, 0xff7f, 0
  v_pk_mov_b32 v[244:245], s[44:45], 0 op_sel:[0,0]
  s_cmp_gt_u32 s42, 5
  s_cselect_b32 s44, 0xff7f, 0
  v_pk_mov_b32 v[246:247], s[44:45], 0 op_sel:[0,0]
  s_cmp_gt_u32 s42, 6
  s_cselect_b32 s44, 0xff7f, 0
  v_pk_mov_b32 v[248:249], s[44:45], 0 op_sel:[0,0]
  s_cmp_gt_u32 s42, 7
  s_cselect_b32 s44, 0xff7f, 0
  v_pk_mov_b32 v[250:251], s[44:45], 0 op_sel:[0,0]
  s_cmp_gt_u32 s42, 8
  s_cselect_b32 s44, 0xff7f, 0
  v_pk_mov_b32 v[252:253], s[44:45], 0 op_sel:[0,0]
  v_mov_b32 v45, v55
  v_mov_b32 v46, v52
  v_mov_b32 v47, v53
  v_mul_u32_u24 v9, 0x3f80, v3
  v_pk_mov_b32 v[184:185], 0, 0
  v_pk_mov_b32 v[186:187], 0, 0
  v_pk_mov_b32 v[188:189], 0, 0
  v_pk_mov_b32 v[190:191], 0, 0
  v_pk_mov_b32 v[192:193], 0, 0
  v_pk_mov_b32 v[194:195], 0, 0
  v_pk_mov_b32 v[196:197], 0, 0
  v_pk_mov_b32 v[198:199], 0, 0
  s_mul_i32 s43, s23, 2560
  v_add_u32 v14, s43, v55
  v_add_u32 v15, s43, v54
  v_add_u32 v30, s43, v53
  s_mov_b32 s53, 0
  s_add_u32 s60, s16, 0x1600000
  s_addc_u32 s61, s17, 0
  s_mov_b32 s62, 0x190000
  s_mov_b32 s63, 0x20000
  s_lshl_b32 s46, s23, 6
  v_add_u32 v12, s46, v0
  v_cmp_gt_u32 vcc, 200, v12
  v_lshlrev_b32 v12, 7, v12
  v_mov_b32 v13, 0x7f000000
  v_cndmask_b32 v12, v13, v12, vcc
  s_and_b32 s46, s2, 1
  s_mul_i32 s46, s46, 819200
  s_mul_i32 s47, s18, 25600
  s_add_u32 s55, s46, s47
  s_mul_i32 s44, s22, 40960
  s_lshl_b32 s45, s20, 10
  s_add_u32 s45, s45, s44
  s_lshr_b32 s46, s20, 2
  s_lshl_b32 s46, s46, 10
  s_and_b32 s47, s20, 3
  s_lshl_b32 s47, s47, 2
  s_add_u32 s46, s46, s47
  s_add_u32 s46, s46, s44
  s_add_u32 s46, s46, 32768
  s_add_u32 s56, s45, 2621440
  s_add_u32 s57, s46, 2621440
  s_mov_b32 s44, 0x71800000
  s_mov_b64 s[48:49], -1
  s_mov_b32 m0, s54
  s_add_u32 s31, s30, 4096
  buffer_load_dwordx4 v51, s[32:35], s30 offen offset:0 lds
  buffer_load_dwordx4 v51, s[32:35], s30 offen offset:1024 lds
  buffer_load_dwordx4 v51, s[32:35], s30 offen offset:2048 lds
  buffer_load_dwordx4 v51, s[32:35], s30 offen offset:3072 lds
  s_add_u32 m0, s54, 4096
  s_add_u32 s30, s30, 40960
  buffer_load_dwordx4 v51, s[32:35], s31 offen lds
  s_add_u32 s54, s54, 40960
  s_mov_b32 s52, 40960
  s_setprio 2
  s_waitcnt vmcnt(5)
  s_barrier
  ds_read2st64_b64 v[32:35], v45 offset0:0 offset1:1
  ds_read2st64_b64 v[40:43], v46 offset0:0 offset1:10
  ds_read2st64_b64 v[36:39], v45 offset0:5 offset1:6
  s_mov_b64 exec, s[40:41]
  ds_read_b128 v[200:203], v47 offset:0
  ds_read_b128 v[204:207], v47 offset:640
  ds_read_b128 v[208:211], v47 offset:2560
  ds_read_b128 v[212:215], v47 offset:3200
  s_mov_b64 exec, -1
  s_waitcnt lgkmcnt(5)
  v_mfma_f32_32x32x16_bf16 v[136:151], v[32:35], v[16:19], 0
  v_mfma_f32_32x32x8_bf16 v[136:151], v[40:41], v[20:21], v[136:151]
  buffer_load_dwordx2 v[24:25], v55, s[32:35], s27 offen
  buffer_load_dwordx2 v[26:27], v55, s[32:35], s27 offen offset:512
  buffer_load_dwordx2 v[28:29], v4, s[32:35], s27 offen offset:1024
  s_nop 9
  s_nop 5
  v_max_f32 v2, v136, v137
  v_max3_f32 v2, v138, v139, v2
  v_max3_f32 v2, v140, v141, v2
  v_max3_f32 v2, v142, v143, v2
  v_max3_f32 v2, v144, v145, v2
  v_max3_f32 v2, v146, v147, v2
  v_max3_f32 v2, v148, v149, v2
  v_max3_f32 v2, v150, v151, v2
  v_mov_b32 v3, v2
  s_nop 1
  v_permlane32_swap_b32 v2, v3
  s_nop 1
  v_max_f32 v2, v2, v3
  v_sub_f32 v3, 0, v2
  v_sub_f32 v2, 0, v2
  v_pk_mov_b32 v[88:89], v[2:3], v[2:3]
  v_pk_mov_b32 v[90:91], v[2:3], v[2:3]
  v_pk_mov_b32 v[92:93], v[2:3], v[2:3]
  v_pk_mov_b32 v[94:95], v[2:3], v[2:3]
  v_pk_mov_b32 v[96:97], v[2:3], v[2:3]
  v_pk_mov_b32 v[98:99], v[2:3], v[2:3]
  v_pk_mov_b32 v[100:101], v[2:3], v[2:3]
  v_pk_mov_b32 v[102:103], v[2:3], v[2:3]
  s_waitcnt lgkmcnt(0)
  v_pk_add_f32 v[136:137], v[136:137], v[2:3]
  v_pk_add_f32 v[138:139], v[138:139], v[2:3]
  v_pk_add_f32 v[140:141], v[140:141], v[2:3]
  v_pk_add_f32 v[142:143], v[142:143], v[2:3]
  v_pk_add_f32 v[144:145], v[144:145], v[2:3]
  v_pk_add_f32 v[146:147], v[146:147], v[2:3]
  v_pk_add_f32 v[148:149], v[148:149], v[2:3]
  v_pk_add_f32 v[150:151], v[150:151], v[2:3]
.p2align 6
L_attn_kernel_aloop:
  s_setprio 1
  v_mfma_f32_32x32x16_bf16 v[152:167], v[36:39], v[16:19], v[88:103]
  ds_read2st64_b64 v[216:219], v45 offset0:10 offset1:11
  ds_read2st64_b64 v[220:223], v45 offset0:15 offset1:16
  s_mov_b32 m0, s54
  v_exp_f32 v136, v136
  v_exp_f32 v137, v137
  v_exp_f32 v138, v138
  v_exp_f32 v139, v139
  v_smfmac_f32_32x32x32_bf16 v[72:87], v[64:67], v[184:191], v44
  buffer_load_dwordx4 v51, s[32:35], s30 offen offset:0 lds
  v_exp_f32 v140, v140
  v_exp_f32 v141, v141
  v_exp_f32 v142, v142
  v_exp_f32 v143, v143
  v_mfma_f32_32x32x8_bf16 v[152:167], v[40:41], v[22:23], v[152:167]
  v_exp_f32 v144, v144
  v_exp_f32 v145, v145
  v_exp_f32 v146, v146
  v_exp_f32 v147, v147
  v_smfmac_f32_32x32x32_bf16 v[72:87], v[68:71], v[192:199], v44
  v_exp_f32 v148, v148
  v_exp_f32 v149, v149
  v_exp_f32 v150, v150
  v_exp_f32 v151, v151
  s_waitcnt lgkmcnt(0)
  v_mfma_f32_32x32x16_bf16 v[168:183], v[216:219], v[16:19], v[88:103]
  v_exp_f32 v152, v152
  v_exp_f32 v153, v153
  v_exp_f32 v154, v154
  v_exp_f32 v155, v155
  v_smfmac_f32_32x32x32_bf16 v[72:87], v[200:203], v[136:143], v44
  s_mov_b64 exec, s[40:41]
  ds_read_b128 v[56:59], v47 offset:5120
  ds_read_b128 v[60:63], v47 offset:5760
  ds_read_b128 v[64:67], v47 offset:7680
  ds_read_b128 v[68:71], v47 offset:8320
  s_mov_b64 exec, -1
  v_exp_f32 v156, v156
  v_exp_f32 v157, v157
  v_exp_f32 v158, v158
  v_exp_f32 v159, v159
  v_mfma_f32_32x32x8_bf16 v[168:183], v[42:43], v[20:21], v[168:183]
  v_exp_f32 v160, v160
  v_exp_f32 v161, v161
  v_exp_f32 v162, v162
  v_exp_f32 v163, v163
  v_smfmac_f32_32x32x32_bf16 v[72:87], v[204:207], v[144:151], v44
  v_exp_f32 v164, v164
  v_exp_f32 v165, v165
  v_exp_f32 v166, v166
  v_exp_f32 v167, v167
  v_mfma_f32_32x32x16_bf16 v[184:199], v[220:223], v[16:19], v[88:103]
  ds_read2st64_b64 v[32:35], v45 offset0:20 offset1:21
  ds_read2st64_b64 v[36:39], v45 offset0:25 offset1:26
  ds_read2st64_b64 v[224:227], v46 offset0:20 offset1:30
  v_exp_f32 v168, v168
  v_exp_f32 v169, v169
  v_exp_f32 v170, v170
  v_exp_f32 v171, v171
  v_smfmac_f32_32x32x32_bf16 v[72:87], v[208:211], v[152:159], v44
  buffer_load_dwordx4 v51, s[32:35], s30 offen offset:1024 lds
  v_exp_f32 v172, v172
  v_exp_f32 v173, v173
  v_exp_f32 v174, v174
  v_exp_f32 v175, v175
  v_mfma_f32_32x32x8_bf16 v[184:199], v[42:43], v[22:23], v[184:199]
  v_add_u32 v48, s52, v55
  v_add_u32 v49, s52, v52
  v_add_u32 v50, s52, v53
  v_exp_f32 v176, v176
  v_exp_f32 v177, v177
  v_exp_f32 v178, v178
  v_exp_f32 v179, v179
  v_smfmac_f32_32x32x32_bf16 v[72:87], v[212:215], v[160:167], v44
  v_exp_f32 v180, v180
  v_exp_f32 v181, v181
  v_exp_f32 v182, v182
  v_exp_f32 v183, v183
  s_waitcnt lgkmcnt(0)
  v_mfma_f32_32x32x16_bf16 v[136:151], v[32:35], v[16:19], v[88:103]
  v_exp_f32 v184, v184
  v_exp_f32 v185, v185
  v_exp_f32 v186, v186
  v_exp_f32 v187, v187
  s_setprio 0
  v_smfmac_f32_32x32x32_bf16 v[72:87], v[56:59], v[168:175], v44
  s_mov_b64 exec, s[40:41]
  ds_read_b128 v[200:203], v47 offset:10240
  ds_read_b128 v[204:207], v47 offset:10880
  ds_read_b128 v[208:211], v47 offset:12800
  ds_read_b128 v[212:215], v47 offset:13440
  s_mov_b64 exec, -1
  v_exp_f32 v188, v188
  v_exp_f32 v189, v189
  v_exp_f32 v190, v190
  v_exp_f32 v191, v191
  v_mfma_f32_32x32x8_bf16 v[136:151], v[224:225], v[20:21], v[136:151]
  v_exp_f32 v192, v192
  v_exp_f32 v193, v193
  v_exp_f32 v194, v194
  v_exp_f32 v195, v195
  v_smfmac_f32_32x32x32_bf16 v[72:87], v[60:63], v[176:183], v44
  v_exp_f32 v196, v196
  v_exp_f32 v197, v197
  v_exp_f32 v198, v198
  v_exp_f32 v199, v199
  s_setprio 1
  v_mfma_f32_32x32x16_bf16 v[152:167], v[36:39], v[16:19], v[88:103]
  ds_read2st64_b64 v[216:219], v45 offset0:30 offset1:31
  ds_read2st64_b64 v[220:223], v45 offset0:35 offset1:36
  v_exp_f32 v136, v136
  v_exp_f32 v137, v137
  v_exp_f32 v138, v138
  v_exp_f32 v139, v139
  v_smfmac_f32_32x32x32_bf16 v[72:87], v[64:67], v[184:191], v44
  buffer_load_dwordx4 v51, s[32:35], s30 offen offset:2048 lds
  v_exp_f32 v140, v140
  v_exp_f32 v141, v141
  v_exp_f32 v142, v142
  v_exp_f32 v143, v143
  v_mfma_f32_32x32x8_bf16 v[152:167], v[224:225], v[22:23], v[152:167]
  v_exp_f32 v144, v144
  v_exp_f32 v145, v145
  v_exp_f32 v146, v146
  v_exp_f32 v147, v147
  v_smfmac_f32_32x32x32_bf16 v[72:87], v[68:71], v[192:199], v44
  v_exp_f32 v148, v148
  v_exp_f32 v149, v149
  v_exp_f32 v150, v150
  v_exp_f32 v151, v151
  s_waitcnt lgkmcnt(0)
  v_mfma_f32_32x32x16_bf16 v[168:183], v[216:219], v[16:19], v[88:103]
  v_exp_f32 v152, v152
  v_exp_f32 v153, v153
  v_exp_f32 v154, v154
  v_exp_f32 v155, v155
  v_smfmac_f32_32x32x32_bf16 v[72:87], v[200:203], v[136:143], v44
  s_mov_b64 exec, s[40:41]
  ds_read_b128 v[56:59], v47 offset:15360
  ds_read_b128 v[60:63], v47 offset:16000
  ds_read_b128 v[64:67], v47 offset:17920
  ds_read_b128 v[68:71], v47 offset:18560
  s_mov_b64 exec, -1
  v_exp_f32 v156, v156
  v_exp_f32 v157, v157
  v_exp_f32 v158, v158
  v_exp_f32 v159, v159
  v_mfma_f32_32x32x8_bf16 v[168:183], v[226:227], v[20:21], v[168:183]
  v_exp_f32 v160, v160
  v_exp_f32 v161, v161
  v_exp_f32 v162, v162
  v_exp_f32 v163, v163
  v_smfmac_f32_32x32x32_bf16 v[72:87], v[204:207], v[144:151], v44
  v_exp_f32 v164, v164
  v_exp_f32 v165, v165
  v_exp_f32 v166, v166
  v_exp_f32 v167, v167
  v_mfma_f32_32x32x16_bf16 v[184:199], v[220:223], v[16:19], v[88:103]
  ds_read2st64_b64 v[32:35], v45 offset0:40 offset1:41
  ds_read2st64_b64 v[36:39], v45 offset0:45 offset1:46
  ds_read2st64_b64 v[40:43], v46 offset0:40 offset1:50
  v_exp_f32 v168, v168
  v_exp_f32 v169, v169
  v_exp_f32 v170, v170
  v_exp_f32 v171, v171
  v_smfmac_f32_32x32x32_bf16 v[72:87], v[208:211], v[152:159], v44
  buffer_load_dwordx4 v51, s[32:35], s30 offen offset:3072 lds
  v_exp_f32 v172, v172
  v_exp_f32 v173, v173
  v_exp_f32 v174, v174
  v_exp_f32 v175, v175
  v_mfma_f32_32x32x8_bf16 v[184:199], v[226:227], v[22:23], v[184:199]
  v_exp_f32 v176, v176
  v_exp_f32 v177, v177
  v_exp_f32 v178, v178
  v_exp_f32 v179, v179
  v_smfmac_f32_32x32x32_bf16 v[72:87], v[212:215], v[160:167], v44
  v_exp_f32 v180, v180
  v_exp_f32 v181, v181
  v_exp_f32 v182, v182
  v_exp_f32 v183, v183
  s_waitcnt lgkmcnt(0)
  v_mfma_f32_32x32x16_bf16 v[136:151], v[32:35], v[16:19], v[88:103]
  v_exp_f32 v184, v184
  v_exp_f32 v185, v185
  v_exp_f32 v186, v186
  v_exp_f32 v187, v187
  s_setprio 0
  v_smfmac_f32_32x32x32_bf16 v[72:87], v[56:59], v[168:175], v44
  s_mov_b64 exec, s[40:41]
  ds_read_b128 v[200:203], v47 offset:20480
  ds_read_b128 v[204:207], v47 offset:21120
  ds_read_b128 v[208:211], v47 offset:23040
  ds_read_b128 v[212:215], v47 offset:23680
  s_mov_b64 exec, -1
  v_exp_f32 v188, v188
  v_exp_f32 v189, v189
  v_exp_f32 v190, v190
  v_exp_f32 v191, v191
  v_mfma_f32_32x32x8_bf16 v[136:151], v[40:41], v[20:21], v[136:151]
  v_exp_f32 v192, v192
  v_exp_f32 v193, v193
  v_exp_f32 v194, v194
  v_exp_f32 v195, v195
  v_smfmac_f32_32x32x32_bf16 v[72:87], v[60:63], v[176:183], v44
  v_exp_f32 v196, v196
  v_exp_f32 v197, v197
  v_exp_f32 v198, v198
  v_exp_f32 v199, v199
  s_setprio 1
  v_mfma_f32_32x32x16_bf16 v[152:167], v[36:39], v[16:19], v[88:103]
  ds_read2st64_b64 v[216:219], v45 offset0:50 offset1:51
  ds_read2st64_b64 v[220:223], v45 offset0:55 offset1:56
  s_add_u32 m0, s54, 4096
  s_add_u32 s31, s30, 4096
  v_exp_f32 v136, v136
  v_exp_f32 v137, v137
  v_exp_f32 v138, v138
  v_exp_f32 v139, v139
  v_smfmac_f32_32x32x32_bf16 v[72:87], v[64:67], v[184:191], v44
  buffer_load_dwordx4 v51, s[32:35], s31 offen lds
  v_exp_f32 v140, v140
  v_exp_f32 v141, v141
  v_exp_f32 v142, v142
  v_exp_f32 v143, v143
  v_mfma_f32_32x32x8_bf16 v[152:167], v[40:41], v[22:23], v[152:167]
  v_exp_f32 v144, v144
  v_exp_f32 v145, v145
  v_exp_f32 v146, v146
  v_exp_f32 v147, v147
  v_smfmac_f32_32x32x32_bf16 v[72:87], v[68:71], v[192:199], v44
  v_exp_f32 v148, v148
  v_exp_f32 v149, v149
  v_exp_f32 v150, v150
  v_exp_f32 v151, v151
  s_waitcnt lgkmcnt(0)
  v_mfma_f32_32x32x16_bf16 v[168:183], v[216:219], v[16:19], v[88:103]
  v_exp_f32 v152, v152
  v_exp_f32 v153, v153
  v_exp_f32 v154, v154
  v_exp_f32 v155, v155
  v_smfmac_f32_32x32x32_bf16 v[72:87], v[200:203], v[136:143], v44
  s_mov_b64 exec, s[40:41]
  ds_read_b128 v[56:59], v47 offset:25600
  ds_read_b128 v[60:63], v47 offset:26240
  ds_read_b128 v[64:67], v47 offset:28160
  ds_read_b128 v[68:71], v47 offset:28800
  s_mov_b64 exec, -1
  v_exp_f32 v156, v156
  v_exp_f32 v157, v157
  v_exp_f32 v158, v158
  v_exp_f32 v159, v159
  v_mfma_f32_32x32x8_bf16 v[168:183], v[42:43], v[20:21], v[168:183]
  v_exp_f32 v160, v160
  v_exp_f32 v161, v161
  v_exp_f32 v162, v162
  v_exp_f32 v163, v163
  v_smfmac_f32_32x32x32_bf16 v[72:87], v[204:207], v[144:151], v44
  v_exp_f32 v164, v164
  v_exp_f32 v165, v165
  v_exp_f32 v166, v166
  v_exp_f32 v167, v167
  v_mfma_f32_32x32x16_bf16 v[184:199], v[220:223], v[16:19], v[88:103]
  ds_read2st64_b64 v[32:35], v45 offset0:60 offset1:61
  ds_read2st64_b64 v[36:39], v45 offset0:65 offset1:66
  ds_read2st64_b64 v[224:227], v46 offset0:60 offset1:70
  v_exp_f32 v168, v168
  v_exp_f32 v169, v169
  v_exp_f32 v170, v170
  v_exp_f32 v171, v171
  v_smfmac_f32_32x32x32_bf16 v[72:87], v[208:211], v[152:159], v44
  s_add_u32 s30, s30, 40960
  s_add_u32 s54, s54, 40960
  s_cmp_eq_u32 s53, 1
  s_cselect_b32 s30, s29, s30
  s_cselect_b32 s54, s28, s54
  s_add_u32 s52, s52, 40960
  s_cmp_eq_u32 s53, 2
  s_cselect_b32 s30, 0x7f000000, s30
  s_cselect_b32 s52, 0, s52
  v_exp_f32 v172, v172
  v_exp_f32 v173, v173
  v_exp_f32 v174, v174
  v_exp_f32 v175, v175
  v_mfma_f32_32x32x8_bf16 v[184:199], v[42:43], v[22:23], v[184:199]
  v_exp_f32 v176, v176
  v_exp_f32 v177, v177
  v_exp_f32 v178, v178
  v_exp_f32 v179, v179
  v_smfmac_f32_32x32x32_bf16 v[72:87], v[212:215], v[160:167], v44
  v_exp_f32 v180, v180
  v_exp_f32 v181, v181
  v_exp_f32 v182, v182
  v_exp_f32 v183, v183
  s_waitcnt lgkmcnt(0)
  v_mfma_f32_32x32x16_bf16 v[136:151], v[32:35], v[16:19], v[88:103]
  v_exp_f32 v184, v184
  v_exp_f32 v185, v185
  v_exp_f32 v186, v186
  v_exp_f32 v187, v187
  s_setprio 0
  v_smfmac_f32_32x32x32_bf16 v[72:87], v[56:59], v[168:175], v44
  s_mov_b64 exec, s[40:41]
  ds_read_b128 v[200:203], v47 offset:30720
  ds_read_b128 v[204:207], v47 offset:31360
  ds_read_b128 v[208:211], v47 offset:33280
  ds_read_b128 v[212:215], v47 offset:33920
  s_mov_b64 exec, -1
  v_exp_f32 v188, v188
  v_exp_f32 v189, v189
  v_exp_f32 v190, v190
  v_exp_f32 v191, v191
  v_mfma_f32_32x32x8_bf16 v[136:151], v[224:225], v[20:21], v[136:151]
  v_exp_f32 v192, v192
  v_exp_f32 v193, v193
  v_exp_f32 v194, v194
  v_exp_f32 v195, v195
  v_smfmac_f32_32x32x32_bf16 v[72:87], v[60:63], v[176:183], v44
  v_exp_f32 v196, v196
  v_exp_f32 v197, v197
  v_exp_f32 v198, v198
  v_exp_f32 v199, v199
  s_setprio 1
  v_mfma_f32_32x32x16_bf16 v[152:167], v[36:39], v[16:19], v[88:103]
  ds_read2st64_b64 v[216:219], v45 offset0:70 offset1:71
  ds_read2st64_b64 v[220:223], v45 offset0:75 offset1:76
  v_exp_f32 v136, v136
  v_exp_f32 v137, v137
  v_exp_f32 v138, v138
  v_exp_f32 v139, v139
  v_smfmac_f32_32x32x32_bf16 v[72:87], v[64:67], v[184:191], v44
  v_exp_f32 v140, v140
  v_exp_f32 v141, v141
  v_exp_f32 v142, v142
  v_exp_f32 v143, v143
  v_mfma_f32_32x32x8_bf16 v[152:167], v[224:225], v[22:23], v[152:167]
  v_exp_f32 v144, v144
  v_exp_f32 v145, v145
  v_exp_f32 v146, v146
  v_exp_f32 v147, v147
  v_smfmac_f32_32x32x32_bf16 v[72:87], v[68:71], v[192:199], v44
  v_exp_f32 v148, v148
  v_exp_f32 v149, v149
  v_exp_f32 v150, v150
  v_exp_f32 v151, v151
  s_waitcnt vmcnt(5) lgkmcnt(0)
  s_barrier
  v_mfma_f32_32x32x16_bf16 v[168:183], v[216:219], v[16:19], v[88:103]
  v_exp_f32 v152, v152
  v_exp_f32 v153, v153
  v_exp_f32 v154, v154
  v_exp_f32 v155, v155
  v_smfmac_f32_32x32x32_bf16 v[72:87], v[200:203], v[136:143], v44
  s_mov_b64 exec, s[40:41]
  ds_read_b128 v[56:59], v47 offset:35840
  ds_read_b128 v[60:63], v47 offset:36480
  ds_read_b128 v[64:67], v47 offset:38400
  ds_read_b128 v[68:71], v47 offset:39040
  s_mov_b64 exec, -1
  v_exp_f32 v156, v156
  v_exp_f32 v157, v157
  v_exp_f32 v158, v158
  v_exp_f32 v159, v159
  v_mfma_f32_32x32x8_bf16 v[168:183], v[226:227], v[20:21], v[168:183]
  v_exp_f32 v160, v160
  v_exp_f32 v161, v161
  v_exp_f32 v162, v162
  v_exp_f32 v163, v163
  v_smfmac_f32_32x32x32_bf16 v[72:87], v[204:207], v[144:151], v44
  v_exp_f32 v164, v164
  v_exp_f32 v165, v165
  v_exp_f32 v166, v166
  v_exp_f32 v167, v167
  v_mfma_f32_32x32x16_bf16 v[184:199], v[220:223], v[16:19], v[88:103]
  ds_read2st64_b64 v[32:35], v48 offset0:0 offset1:1
  ds_read2st64_b64 v[36:39], v48 offset0:5 offset1:6
  ds_read2st64_b64 v[40:43], v49 offset0:0 offset1:10
  v_exp_f32 v168, v168
  v_exp_f32 v169, v169
  v_exp_f32 v170, v170
  v_exp_f32 v171, v171
  v_smfmac_f32_32x32x32_bf16 v[72:87], v[208:211], v[152:159], v44
  ds_read2st64_b64 v[232:235], v14 offset0:40 offset1:41
  ds_read2st64_b64 v[228:231], v14 offset0:35 offset1:36
  s_mov_b32 exec_hi, 0
  ds_read_b64 v[252:253], v15 offset:20480
  ds_read_b64 v[250:251], v15 offset:17920
  s_mov_b64 exec, -1
  v_or_b32 v28, v28, v9
  v_exp_f32 v172, v172
  v_exp_f32 v173, v173
  v_exp_f32 v174, v174
  v_exp_f32 v175, v175
  v_mfma_f32_32x32x8_bf16 v[184:199], v[226:227], v[22:23], v[184:199]
  v_exp_f32 v176, v176
  v_exp_f32 v177, v177
  v_exp_f32 v178, v178
  v_exp_f32 v179, v179
  v_smfmac_f32_32x32x32_bf16 v[72:87], v[212:215], v[160:167], v44
  v_exp_f32 v180, v180
  v_exp_f32 v181, v181
  v_exp_f32 v182, v182
  v_exp_f32 v183, v183
  s_waitcnt lgkmcnt(0)
  v_mfma_f32_32x32x16_bf16 v[136:151], v[32:35], v[16:19], v[88:103]
  v_exp_f32 v184, v184
  v_exp_f32 v185, v185
  v_exp_f32 v186, v186
  v_exp_f32 v187, v187
  s_setprio 0
  v_smfmac_f32_32x32x32_bf16 v[72:87], v[56:59], v[168:175], v44
  s_mov_b64 exec, s[40:41]
  ds_read_b128 v[200:203], v50 offset:0
  ds_read_b128 v[204:207], v50 offset:640
  ds_read_b128 v[208:211], v50 offset:2560
  ds_read_b128 v[212:215], v50 offset:3200
  s_mov_b64 exec, -1
  v_exp_f32 v188, v188
  v_exp_f32 v189, v189
  v_exp_f32 v190, v190
  v_exp_f32 v191, v191
  v_mfma_f32_32x32x8_bf16 v[136:151], v[40:41], v[20:21], v[136:151]
  v_exp_f32 v192, v192
  v_exp_f32 v193, v193
  v_exp_f32 v194, v194
  v_exp_f32 v195, v195
  v_mov_b32 v45, v48
  v_mov_b32 v46, v49
  v_mov_b32 v47, v50
  s_add_u32 s53, s53, 1
  s_cmp_lt_u32 s53, 4
  v_smfmac_f32_32x32x32_bf16 v[72:87], v[60:63], v[176:183], v44
  v_exp_f32 v196, v196
  v_exp_f32 v197, v197
  v_exp_f32 v198, v198
  v_exp_f32 v199, v199
  s_cbranch_scc1 L_attn_kernel_aloop
  s_setprio 2
  buffer_load_dword v13, v12, s[60:63], s55 offen
  v_smfmac_f32_32x32x32_bf16 v[72:87], v[64:67], v[184:191], v44
  v_mfma_f32_32x32x16_bf16 v[152:167], v[228:231], v[24:27], 0
  v_smfmac_f32_32x32x32_bf16 v[72:87], v[68:71], v[192:199], v44
  v_mfma_f32_32x32x16_bf16 v[136:151], v[232:235], v[24:27], v[104:119]
  v_mfma_f32_32x32x8_bf16 v[152:167], v[250:251], v[28:29], v[152:167]
  v_mfma_f32_32x32x8_bf16 v[136:151], v[252:253], v[28:29], v[136:151]
  s_waitcnt lgkmcnt(0)
  ds_read2st64_b64 v[224:227], v14 offset0:30 offset1:31
  ds_read2st64_b64 v[220:223], v14 offset0:25 offset1:26
  ds_read2st64_b64 v[216:219], v14 offset0:20 offset1:21
  ds_read2st64_b64 v[212:215], v14 offset0:15 offset1:16
  ds_read2st64_b64 v[208:211], v14 offset0:10 offset1:11
  ds_read2st64_b64 v[204:207], v14 offset0:5 offset1:6
  ds_read2st64_b64 v[200:203], v14 offset0:0 offset1:1
  s_mov_b32 exec_hi, 0
  ds_read_b64 v[248:249], v15 offset:15360
  ds_read_b64 v[246:247], v15 offset:12800
  ds_read_b64 v[244:245], v15 offset:10240
  ds_read_b64 v[242:243], v15 offset:7680
  ds_read_b64 v[240:241], v15 offset:5120
  ds_read_b64 v[238:239], v15 offset:2560
  ds_read_b64 v[236:237], v15 offset:0
  s_mov_b64 exec, -1
  v_pk_mul_f32 v[10:11], v[72:73], 0
  v_pk_fma_f32 v[10:11], v[74:75], 0, v[10:11]
  v_pk_fma_f32 v[10:11], v[76:77], 0, v[10:11]
  v_pk_fma_f32 v[10:11], v[78:79], 0, v[10:11]
  v_pk_fma_f32 v[10:11], v[80:81], 0, v[10:11]
  v_add_f32 v10, v10, v82
  v_add_f32 v10, v10, v11
  v_cmp_ngt_f32 vcc, s44, v10
  v_max_f32 v2, v152, v153
  v_max3_f32 v2, v154, v155, v2
  v_max3_f32 v2, v156, v157, v2
  v_max3_f32 v2, v158, v159, v2
  v_max3_f32 v2, v160, v161, v2
  v_max3_f32 v2, v162, v163, v2
  v_max3_f32 v2, v164, v165, v2
  v_max3_f32 v2, v166, v167, v2
  s_cbranch_vccnz L_attn_kernel_aslow
L_attn_kernel_afin:
  v_rcp_f32 v10, v82
  v_max3_f32 v2, v136, v137, v2
  v_max3_f32 v2, v138, v139, v2
  v_max3_f32 v2, v140, v141, v2
  v_max3_f32 v2, v142, v143, v2
  v_max3_f32 v2, v144, v145, v2
  v_max3_f32 v2, v146, v147, v2
  v_max3_f32 v2, v148, v149, v2
  v_max3_f32 v2, v150, v151, v2
  v_pk_mul_f32 v[72:73], v[72:73], v[10:11] op_sel_hi:[1,0]
  v_pk_mul_f32 v[74:75], v[74:75], v[10:11] op_sel_hi:[1,0]
  v_pk_mul_f32 v[76:77], v[76:77], v[10:11] op_sel_hi:[1,0]
  v_pk_mul_f32 v[78:79], v[78:79], v[10:11] op_sel_hi:[1,0]
  v_pk_mul_f32 v[80:81], v[80:81], v[10:11] op_sel_hi:[1,0]
  v_cvt_pk_bf16_f32 v4, v72, v73
  v_cvt_pk_bf16_f32 v5, v74, v75
  v_cvt_pk_bf16_f32 v6, v76, v77
  v_cvt_pk_bf16_f32 v7, v78, v79
  v_cvt_pk_bf16_f32 v8, v80, v81
  buffer_store_dwordx4 v[4:7], v51, s[36:39], s45 offen
  buffer_store_dword v8, v51, s[36:39], s46 offen
  v_mov_b32 v3, v2
  s_nop 1
  v_permlane32_swap_b32 v2, v3
  s_nop 1
  v_max_f32 v2, v2, v3
  v_sub_f32 v3, 0xc2700000, v2
  v_sub_f32 v2, 0xc2700000, v2
L_attn_kernel_bp2:
  s_waitcnt lgkmcnt(0)
  s_mov_b64 exec, s[40:41]
  ds_read_b128 v[56:59], v30 offset:20480
  ds_read_b128 v[60:63], v30 offset:21120
  s_mov_b64 exec, -1
  v_pk_mov_b32 v[88:89], v[2:3], v[2:3]
  v_pk_mov_b32 v[90:91], v[2:3], v[2:3]
  v_pk_mov_b32 v[92:93], v[2:3], v[2:3]
  v_pk_mov_b32 v[94:95], v[2:3], v[2:3]
  v_pk_mov_b32 v[96:97], v[2:3], v[2:3]
  v_pk_mov_b32 v[98:99], v[2:3], v[2:3]
  v_pk_mov_b32 v[100:101], v[2:3], v[2:3]
  v_pk_mov_b32 v[102:103], v[2:3], v[2:3]
  v_pk_add_f32 v[136:137], v[136:137], v[2:3]
  v_pk_add_f32 v[138:139], v[138:139], v[2:3]
  v_pk_add_f32 v[140:141], v[140:141], v[2:3]
  v_pk_add_f32 v[142:143], v[142:143], v[2:3]
  v_pk_add_f32 v[144:145], v[144:145], v[2:3]
  v_pk_add_f32 v[146:147], v[146:147], v[2:3]
  v_pk_add_f32 v[148:149], v[148:149], v[2:3]
  v_pk_add_f32 v[150:151], v[150:151], v[2:3]
  v_pk_mov_b32 v[72:73], 0, 0
  v_pk_mov_b32 v[74:75], 0, 0
  v_pk_mov_b32 v[76:77], 0, 0
  v_pk_mov_b32 v[78:79], 0, 0
  v_pk_mov_b32 v[80:81], 0, 0
  v_pk_mov_b32 v[82:83], 0, 0
  v_pk_add_f32 v[152:153], v[152:153], v[2:3]
  v_pk_add_f32 v[154:155], v[154:155], v[2:3]
  v_pk_add_f32 v[156:157], v[156:157], v[2:3]
  v_pk_add_f32 v[158:159], v[158:159], v[2:3]
  v_pk_add_f32 v[160:161], v[160:161], v[2:3]
  v_pk_add_f32 v[162:163], v[162:163], v[2:3]
  v_pk_add_f32 v[164:165], v[164:165], v[2:3]
  v_pk_add_f32 v[166:167], v[166:167], v[2:3]
  v_pk_add_f32 v[120:121], v[120:121], v[2:3]
  v_pk_add_f32 v[122:123], v[122:123], v[2:3]
  v_pk_add_f32 v[124:125], v[124:125], v[2:3]
  v_pk_add_f32 v[126:127], v[126:127], v[2:3]
  v_pk_add_f32 v[128:129], v[128:129], v[2:3]
  v_pk_add_f32 v[130:131], v[130:131], v[2:3]
  v_pk_add_f32 v[132:133], v[132:133], v[2:3]
  v_pk_add_f32 v[134:135], v[134:135], v[2:3]
  s_setprio 1
  v_exp_f32 v136, v136
  v_exp_f32 v137, v137
  v_exp_f32 v138, v138
  v_exp_f32 v139, v139
  v_exp_f32 v140, v140
  v_exp_f32 v141, v141
  v_exp_f32 v142, v142
  v_exp_f32 v143, v143
  v_exp_f32 v144, v144
  v_exp_f32 v145, v145
  v_exp_f32 v146, v146
  v_exp_f32 v147, v147
  v_exp_f32 v148, v148
  v_exp_f32 v149, v149
  v_exp_f32 v150, v150
  v_exp_f32 v151, v151
  s_waitcnt lgkmcnt(0)
  v_mfma_f32_32x32x16_bf16 v[168:183], v[224:227], v[24:27], v[88:103]
  s_mov_b64 exec, s[40:41]
  ds_read_b128 v[64:67], v30 offset:17920
  ds_read_b128 v[68:71], v30 offset:18560
  s_mov_b64 exec, -1
  v_exp_f32 v152, v152
  v_exp_f32 v153, v153
  v_exp_f32 v154, v154
  v_exp_f32 v155, v155
  v_smfmac_f32_32x32x32_bf16 v[72:87], v[56:59], v[136:143], v44
  v_exp_f32 v156, v156
  v_exp_f32 v157, v157
  v_exp_f32 v158, v158
  v_exp_f32 v159, v159
  v_mfma_f32_32x32x8_bf16 v[168:183], v[248:249], v[28:29], v[168:183]
  v_exp_f32 v160, v160
  v_exp_f32 v161, v161
  v_exp_f32 v162, v162
  v_exp_f32 v163, v163
  v_smfmac_f32_32x32x32_bf16 v[72:87], v[60:63], v[144:151], v44
  v_exp_f32 v164, v164
  v_exp_f32 v165, v165
  v_exp_f32 v166, v166
  v_exp_f32 v167, v167
  s_waitcnt lgkmcnt(0)
  v_mfma_f32_32x32x16_bf16 v[184:199], v[220:223], v[24:27], v[88:103]
  s_mov_b64 exec, s[40:41]
  ds_read_b128 v[56:59], v30 offset:15360
  ds_read_b128 v[60:63], v30 offset:16000
  s_mov_b64 exec, -1
  v_exp_f32 v168, v168
  v_exp_f32 v169, v169
  v_exp_f32 v170, v170
  v_exp_f32 v171, v171
  v_smfmac_f32_32x32x32_bf16 v[72:87], v[64:67], v[152:159], v44
  v_exp_f32 v172, v172
  v_exp_f32 v173, v173
  v_exp_f32 v174, v174
  v_exp_f32 v175, v175
  v_mfma_f32_32x32x8_bf16 v[184:199], v[246:247], v[28:29], v[184:199]
  v_exp_f32 v176, v176
  v_exp_f32 v177, v177
  v_exp_f32 v178, v178
  v_exp_f32 v179, v179
  v_smfmac_f32_32x32x32_bf16 v[72:87], v[68:71], v[160:167], v44
  v_exp_f32 v180, v180
  v_exp_f32 v181, v181
  v_exp_f32 v182, v182
  v_exp_f32 v183, v183
  s_waitcnt lgkmcnt(0)
  v_mfma_f32_32x32x16_bf16 v[136:151], v[216:219], v[24:27], v[88:103]
  s_mov_b64 exec, s[40:41]
  ds_read_b128 v[64:67], v30 offset:12800
  ds_read_b128 v[68:71], v30 offset:13440
  s_mov_b64 exec, -1
  v_exp_f32 v184, v184
  v_exp_f32 v185, v185
  v_exp_f32 v186, v186
  v_exp_f32 v187, v187
  v_smfmac_f32_32x32x32_bf16 v[72:87], v[56:59], v[168:175], v44
  v_exp_f32 v188, v188
  v_exp_f32 v189, v189
  v_exp_f32 v190, v190
  v_exp_f32 v191, v191
  s_setprio 0
  v_mfma_f32_32x32x8_bf16 v[136:151], v[244:245], v[28:29], v[136:151]
  v_exp_f32 v192, v192
  v_exp_f32 v193, v193
  v_exp_f32 v194, v194
  v_exp_f32 v195, v195
  v_smfmac_f32_32x32x32_bf16 v[72:87], v[60:63], v[176:183], v44
  v_exp_f32 v196, v196
  v_exp_f32 v197, v197
  v_exp_f32 v198, v198
  v_exp_f32 v199, v199
  s_waitcnt lgkmcnt(0)
  v_mfma_f32_32x32x16_bf16 v[152:167], v[212:215], v[24:27], v[88:103]
  s_mov_b64 exec, s[40:41]
  ds_read_b128 v[56:59], v30 offset:10240
  ds_read_b128 v[60:63], v30 offset:10880
  s_mov_b64 exec, -1
  v_exp_f32 v136, v136
  v_exp_f32 v137, v137
  v_exp_f32 v138, v138
  v_exp_f32 v139, v139
  v_smfmac_f32_32x32x32_bf16 v[72:87], v[64:67], v[184:191], v44
  v_exp_f32 v140, v140
  v_exp_f32 v141, v141
  v_exp_f32 v142, v142
  v_exp_f32 v143, v143
  s_setprio 1
  v_mfma_f32_32x32x8_bf16 v[152:167], v[242:243], v[28:29], v[152:167]
  v_exp_f32 v144, v144
  v_exp_f32 v145, v145
  v_exp_f32 v146, v146
  v_exp_f32 v147, v147
  v_smfmac_f32_32x32x32_bf16 v[72:87], v[68:71], v[192:199], v44
  v_exp_f32 v148, v148
  v_exp_f32 v149, v149
  v_exp_f32 v150, v150
  v_exp_f32 v151, v151
  s_waitcnt lgkmcnt(0)
  v_mfma_f32_32x32x16_bf16 v[168:183], v[208:211], v[24:27], v[88:103]
  s_mov_b64 exec, s[40:41]
  ds_read_b128 v[64:67], v30 offset:7680
  ds_read_b128 v[68:71], v30 offset:8320
  s_mov_b64 exec, -1
  v_exp_f32 v152, v152
  v_exp_f32 v153, v153
  v_exp_f32 v154, v154
  v_exp_f32 v155, v155
  v_smfmac_f32_32x32x32_bf16 v[72:87], v[56:59], v[136:143], v44
  v_exp_f32 v156, v156
  v_exp_f32 v157, v157
  v_exp_f32 v158, v158
  v_exp_f32 v159, v159
  v_mfma_f32_32x32x8_bf16 v[168:183], v[240:241], v[28:29], v[168:183]
  v_exp_f32 v160, v160
  v_exp_f32 v161, v161
  v_exp_f32 v162, v162
  v_exp_f32 v163, v163
  v_smfmac_f32_32x32x32_bf16 v[72:87], v[60:63], v[144:151], v44
  v_exp_f32 v164, v164
  v_exp_f32 v165, v165
  v_exp_f32 v166, v166
  v_exp_f32 v167, v167
  s_waitcnt lgkmcnt(0)
  v_mfma_f32_32x32x16_bf16 v[184:199], v[204:207], v[24:27], v[88:103]
  s_mov_b64 exec, s[40:41]
  ds_read_b128 v[56:59], v30 offset:5120
  ds_read_b128 v[60:63], v30 offset:5760
  s_mov_b64 exec, -1
  v_exp_f32 v168, v168
  v_exp_f32 v169, v169
  v_exp_f32 v170, v170
  v_exp_f32 v171, v171
  v_smfmac_f32_32x32x32_bf16 v[72:87], v[64:67], v[152:159], v44
  v_exp_f32 v172, v172
  v_exp_f32 v173, v173
  v_exp_f32 v174, v174
  v_exp_f32 v175, v175
  v_mfma_f32_32x32x8_bf16 v[184:199], v[238:239], v[28:29], v[184:199]
  v_exp_f32 v176, v176
  v_exp_f32 v177, v177
  v_exp_f32 v178, v178
  v_exp_f32 v179, v179
  v_smfmac_f32_32x32x32_bf16 v[72:87], v[68:71], v[160:167], v44
  v_exp_f32 v180, v180
  v_exp_f32 v181, v181
  v_exp_f32 v182, v182
  v_exp_f32 v183, v183
  s_waitcnt lgkmcnt(0)
  v_mfma_f32_32x32x16_bf16 v[136:151], v[200:203], v[24:27], v[120:135]
  s_mov_b64 exec, s[40:41]
  ds_read_b128 v[64:67], v30 offset:2560
  ds_read_b128 v[68:71], v30 offset:3200
  s_mov_b64 exec, -1
  v_exp_f32 v184, v184
  v_exp_f32 v185, v185
  v_exp_f32 v186, v186
  v_exp_f32 v187, v187
  v_smfmac_f32_32x32x32_bf16 v[72:87], v[56:59], v[168:175], v44
  v_exp_f32 v188, v188
  v_exp_f32 v189, v189
  v_exp_f32 v190, v190
  v_exp_f32 v191, v191
  v_mfma_f32_32x32x8_bf16 v[136:151], v[236:237], v[28:29], v[136:151]
  v_exp_f32 v192, v192
  v_exp_f32 v193, v193
  v_exp_f32 v194, v194
  v_exp_f32 v195, v195
  v_smfmac_f32_32x32x32_bf16 v[72:87], v[60:63], v[176:183], v44
  v_exp_f32 v196, v196
  v_exp_f32 v197, v197
  v_exp_f32 v198, v198
  v_exp_f32 v199, v199
  s_waitcnt lgkmcnt(0)
  s_setprio 0
  s_mov_b64 exec, s[40:41]
  ds_read_b128 v[56:59], v30 offset:0
  ds_read_b128 v[60:63], v30 offset:640
  s_mov_b64 exec, -1
  v_exp_f32 v136, v136
  v_exp_f32 v137, v137
  v_exp_f32 v138, v138
  v_exp_f32 v139, v139
  v_smfmac_f32_32x32x32_bf16 v[72:87], v[64:67], v[184:191], v44
  v_exp_f32 v140, v140
  v_exp_f32 v141, v141
  v_exp_f32 v142, v142
  v_exp_f32 v143, v143
  v_exp_f32 v144, v144
  v_exp_f32 v145, v145
  v_exp_f32 v146, v146
  v_exp_f32 v147, v147
  v_smfmac_f32_32x32x32_bf16 v[72:87], v[68:71], v[192:199], v44
  v_exp_f32 v148, v148
  v_exp_f32 v149, v149
  v_exp_f32 v150, v150
  v_exp_f32 v151, v151
  s_waitcnt lgkmcnt(0)
  s_setprio 2
  v_smfmac_f32_32x32x32_bf16 v[72:87], v[56:59], v[136:143], v44
  v_smfmac_f32_32x32x32_bf16 v[72:87], v[60:63], v[144:151], v44
  s_nop 15
  v_pk_mul_f32 v[10:11], v[72:73], 0
  v_pk_fma_f32 v[10:11], v[74:75], 0, v[10:11]
  v_pk_fma_f32 v[10:11], v[76:77], 0, v[10:11]
  v_pk_fma_f32 v[10:11], v[78:79], 0, v[10:11]
  v_pk_fma_f32 v[10:11], v[80:81], 0, v[10:11]
  v_add_f32 v10, v10, v82
  v_add_f32 v10, v10, v11
  v_cmp_ngt_f32 vcc, s44, v10
  v_rcp_f32 v10, v82
  s_nop 0
  v_pk_mul_f32 v[72:73], v[72:73], v[10:11] op_sel_hi:[1,0]
  v_pk_mul_f32 v[74:75], v[74:75], v[10:11] op_sel_hi:[1,0]
  v_pk_mul_f32 v[76:77], v[76:77], v[10:11] op_sel_hi:[1,0]
  v_pk_mul_f32 v[78:79], v[78:79], v[10:11] op_sel_hi:[1,0]
  v_pk_mul_f32 v[80:81], v[80:81], v[10:11] op_sel_hi:[1,0]
  s_and_b64 s[58:59], vcc, s[48:49]
  s_cbranch_scc1 L_attn_kernel_bslow
  v_cvt_pk_bf16_f32 v4, v72, v73
  v_cvt_pk_bf16_f32 v5, v74, v75
  v_cvt_pk_bf16_f32 v6, v76, v77
  v_cvt_pk_bf16_f32 v7, v78, v79
  v_cvt_pk_bf16_f32 v8, v80, v81
  buffer_store_dwordx4 v[4:7], v51, s[36:39], s56 offen
  buffer_store_dword v8, v51, s[36:39], s57 offen
L_attn_kernel_end:
  s_endpgm
L_attn_kernel_bslow:
  s_mov_b64 s[48:49], 0
  v_sub_f32 v120, v120, v2
  v_sub_f32 v121, v121, v2
  v_sub_f32 v122, v122, v2
  v_sub_f32 v123, v123, v2
  v_sub_f32 v124, v124, v2
  v_sub_f32 v125, v125, v2
  v_sub_f32 v126, v126, v2
  v_sub_f32 v127, v127, v2
  v_sub_f32 v128, v128, v2
  v_sub_f32 v129, v129, v2
  v_sub_f32 v130, v130, v2
  v_sub_f32 v131, v131, v2
  v_sub_f32 v132, v132, v2
  v_sub_f32 v133, v133, v2
  v_sub_f32 v134, v134, v2
  v_sub_f32 v135, v135, v2
  s_nop 1
  v_mfma_f32_32x32x16_bf16 v[136:151], v[200:203], v[24:27], v[120:135]
  v_mfma_f32_32x32x8_bf16 v[136:151], v[236:237], v[28:29], v[136:151]
  s_nop 15
  s_nop 3
  v_max_f32 v2, v136, v137
  v_max3_f32 v2, v138, v139, v2
  v_max3_f32 v2, v140, v141, v2
  v_max3_f32 v2, v142, v143, v2
  v_max3_f32 v2, v144, v145, v2
  v_max3_f32 v2, v146, v147, v2
  v_max3_f32 v2, v148, v149, v2
  v_max3_f32 v2, v150, v151, v2
  v_mfma_f32_32x32x16_bf16 v[184:199], v[204:207], v[24:27], 0
  v_mfma_f32_32x32x8_bf16 v[184:199], v[238:239], v[28:29], v[184:199]
  s_nop 15
  s_nop 3
  v_max3_f32 v2, v184, v185, v2
  v_max3_f32 v2, v186, v187, v2
  v_max3_f32 v2, v188, v189, v2
  v_max3_f32 v2, v190, v191, v2
  v_max3_f32 v2, v192, v193, v2
  v_max3_f32 v2, v194, v195, v2
  v_max3_f32 v2, v196, v197, v2
  v_max3_f32 v2, v198, v199, v2
  v_mfma_f32_32x32x16_bf16 v[168:183], v[208:211], v[24:27], 0
  v_mfma_f32_32x32x8_bf16 v[168:183], v[240:241], v[28:29], v[168:183]
  s_nop 15
  s_nop 3
  v_max3_f32 v2, v168, v169, v2
  v_max3_f32 v2, v170, v171, v2
  v_max3_f32 v2, v172, v173, v2
  v_max3_f32 v2, v174, v175, v2
  v_max3_f32 v2, v176, v177, v2
  v_max3_f32 v2, v178, v179, v2
  v_max3_f32 v2, v180, v181, v2
  v_max3_f32 v2, v182, v183, v2
  v_mfma_f32_32x32x16_bf16 v[152:167], v[212:215], v[24:27], 0
  v_mfma_f32_32x32x8_bf16 v[152:167], v[242:243], v[28:29], v[152:167]
  s_nop 15
  s_nop 3
  v_max3_f32 v2, v152, v153, v2
  v_max3_f32 v2, v154, v155, v2
  v_max3_f32 v2, v156, v157, v2
  v_max3_f32 v2, v158, v159, v2
  v_max3_f32 v2, v160, v161, v2
  v_max3_f32 v2, v162, v163, v2
  v_max3_f32 v2, v164, v165, v2
  v_max3_f32 v2, v166, v167, v2
  v_mfma_f32_32x32x16_bf16 v[136:151], v[216:219], v[24:27], 0
  v_mfma_f32_32x32x8_bf16 v[136:151], v[244:245], v[28:29], v[136:151]
  s_nop 15
  s_nop 3
  v_max3_f32 v2, v136, v137, v2
  v_max3_f32 v2, v138, v139, v2
  v_max3_f32 v2, v140, v141, v2
  v_max3_f32 v2, v142, v143, v2
  v_max3_f32 v2, v144, v145, v2
  v_max3_f32 v2, v146, v147, v2
  v_max3_f32 v2, v148, v149, v2
  v_max3_f32 v2, v150, v151, v2
  v_mfma_f32_32x32x16_bf16 v[184:199], v[220:223], v[24:27], 0
  v_mfma_f32_32x32x8_bf16 v[184:199], v[246:247], v[28:29], v[184:199]
  s_nop 15
  s_nop 3
  v_max3_f32 v2, v184, v185, v2
  v_max3_f32 v2, v186, v187, v2
  v_max3_f32 v2, v188, v189, v2
  v_max3_f32 v2, v190, v191, v2
  v_max3_f32 v2, v192, v193, v2
  v_max3_f32 v2, v194, v195, v2
  v_max3_f32 v2, v196, v197, v2
  v_max3_f32 v2, v198, v199, v2
  v_mfma_f32_32x32x16_bf16 v[168:183], v[224:227], v[24:27], 0
  v_mfma_f32_32x32x8_bf16 v[168:183], v[248:249], v[28:29], v[168:183]
  s_nop 15
  s_nop 3
  v_max3_f32 v2, v168, v169, v2
  v_max3_f32 v2, v170, v171, v2
  v_max3_f32 v2, v172, v173, v2
  v_max3_f32 v2, v174, v175, v2
  v_max3_f32 v2, v176, v177, v2
  v_max3_f32 v2, v178, v179, v2
  v_max3_f32 v2, v180, v181, v2
  v_max3_f32 v2, v182, v183, v2
  v_mfma_f32_32x32x16_bf16 v[152:167], v[228:231], v[24:27], 0
  v_mfma_f32_32x32x8_bf16 v[152:167], v[250:251], v[28:29], v[152:167]
  s_nop 15
  s_nop 3
  v_max3_f32 v2, v152, v153, v2
  v_max3_f32 v2, v154, v155, v2
  v_max3_f32 v2, v156, v157, v2
  v_max3_f32 v2, v158, v159, v2
  v_max3_f32 v2, v160, v161, v2
  v_max3_f32 v2, v162, v163, v2
  v_max3_f32 v2, v164, v165, v2
  v_max3_f32 v2, v166, v167, v2
  v_mfma_f32_32x32x16_bf16 v[136:151], v[232:235], v[24:27], v[104:119]
  v_mfma_f32_32x32x8_bf16 v[136:151], v[252:253], v[28:29], v[136:151]
  s_nop 15
  s_nop 3
  v_max3_f32 v2, v136, v137, v2
  v_max3_f32 v2, v138, v139, v2
  v_max3_f32 v2, v140, v141, v2
  v_max3_f32 v2, v142, v143, v2
  v_max3_f32 v2, v144, v145, v2
  v_max3_f32 v2, v146, v147, v2
  v_max3_f32 v2, v148, v149, v2
  v_max3_f32 v2, v150, v151, v2
  v_mov_b32 v3, v2
  s_nop 1
  v_permlane32_swap_b32 v2, v3
  s_nop 1
  v_max_f32 v2, v2, v3
  v_sub_f32 v3, 0, v2
  v_sub_f32 v2, 0, v2
  s_branch L_attn_kernel_bp2
L_attn_kernel_aslow:
  s_mov_b32 s52, s24
  s_mov_b32 s50, 64
  v_mov_b32 v2, 0xff800000
L_attn_kernel_as1:
  buffer_load_dwordx2 v[32:33], v55, s[32:35], s52 offen
  buffer_load_dwordx2 v[34:35], v55, s[32:35], s52 offen offset:512
  buffer_load_dwordx2 v[40:41], v54, s[32:35], s52 offen
  s_add_u32 s52, s52, 2560
  s_waitcnt vmcnt(0)
  v_mfma_f32_32x32x16_bf16 v[168:183], v[32:35], v[16:19], 0
  v_mfma_f32_32x32x8_bf16 v[168:183], v[40:41], v[20:21], v[168:183]
  s_sub_u32 s50, s50, 1
  s_cmp_lg_u32 s50, 0
  s_nop 15
  s_nop 3
  v_max3_f32 v2, v168, v169, v2
  v_max3_f32 v2, v170, v171, v2
  v_max3_f32 v2, v172, v173, v2
  v_max3_f32 v2, v174, v175, v2
  v_max3_f32 v2, v176, v177, v2
  v_max3_f32 v2, v178, v179, v2
  v_max3_f32 v2, v180, v181, v2
  v_max3_f32 v2, v182, v183, v2
  s_cbranch_scc1 L_attn_kernel_as1
  v_mov_b32 v3, v2
  s_nop 1
  v_permlane32_swap_b32 v2, v3
  s_nop 1
  v_max_f32 v2, v2, v3
  v_sub_f32 v3, 0, v2
  v_sub_f32 v2, 0, v2
  v_pk_mov_b32 v[88:89], v[2:3], v[2:3]
  v_pk_mov_b32 v[90:91], v[2:3], v[2:3]
  v_pk_mov_b32 v[92:93], v[2:3], v[2:3]
  v_pk_mov_b32 v[94:95], v[2:3], v[2:3]
  v_pk_mov_b32 v[96:97], v[2:3], v[2:3]
  v_pk_mov_b32 v[98:99], v[2:3], v[2:3]
  v_pk_mov_b32 v[100:101], v[2:3], v[2:3]
  v_pk_mov_b32 v[102:103], v[2:3], v[2:3]
  v_mov_b32 v72, 0
  v_mov_b32 v73, 0
  v_mov_b32 v74, 0
  v_mov_b32 v75, 0
  v_mov_b32 v76, 0
  v_mov_b32 v77, 0
  v_mov_b32 v78, 0
  v_mov_b32 v79, 0
  v_mov_b32 v80, 0
  v_mov_b32 v81, 0
  v_mov_b32 v82, 0
  v_mov_b32 v83, 0
  v_mov_b32 v84, 0
  v_mov_b32 v85, 0
  v_mov_b32 v86, 0
  v_mov_b32 v87, 0
  s_mov_b32 s52, s24
  s_mov_b32 s50, 64
L_attn_kernel_as2:
  buffer_load_dwordx2 v[32:33], v55, s[32:35], s52 offen
  buffer_load_dwordx2 v[34:35], v55, s[32:35], s52 offen offset:512
  buffer_load_dwordx2 v[40:41], v54, s[32:35], s52 offen
  s_mov_b64 exec, s[40:41]
  buffer_load_dwordx4 v[56:59], v53, s[32:35], s52 offen
  buffer_load_dwordx4 v[60:63], v53, s[32:35], s52 offen offset:640
  s_mov_b64 exec, -1
  s_add_u32 s52, s52, 2560
  s_waitcnt vmcnt(0)
  v_mfma_f32_32x32x16_bf16 v[168:183], v[32:35], v[16:19], v[88:103]
  v_mfma_f32_32x32x8_bf16 v[168:183], v[40:41], v[20:21], v[168:183]
  s_sub_u32 s50, s50, 1
  s_cmp_lg_u32 s50, 0
  s_nop 15
  s_nop 3
  v_exp_f32 v168, v168
  v_exp_f32 v169, v169
  v_exp_f32 v170, v170
  v_exp_f32 v171, v171
  v_exp_f32 v172, v172
  v_exp_f32 v173, v173
  v_exp_f32 v174, v174
  v_exp_f32 v175, v175
  v_exp_f32 v176, v176
  v_exp_f32 v177, v177
  v_exp_f32 v178, v178
  v_exp_f32 v179, v179
  v_exp_f32 v180, v180
  v_exp_f32 v181, v181
  v_exp_f32 v182, v182
  v_exp_f32 v183, v183
  s_nop 3
  v_smfmac_f32_32x32x32_bf16 v[72:87], v[56:59], v[168:175], v44
  v_smfmac_f32_32x32x32_bf16 v[72:87], v[60:63], v[176:183], v44
  s_nop 15
  s_nop 3
  s_cbranch_scc1 L_attn_kernel_as2
  v_max_f32 v2, v152, v153
  v_max3_f32 v2, v154, v155, v2
  v_max3_f32 v2, v156, v157, v2
  v_max3_f32 v2, v158, v159, v2
  v_max3_f32 v2, v160, v161, v2
  v_max3_f32 v2, v162, v163, v2
  v_max3_f32 v2, v164, v165, v2
  v_max3_f32 v2, v166, v167, v2
  s_branch L_attn_kernel_afin
.globl oproj_kernel
.p2align 8
.type oproj_kernel,@function
oproj_kernel:
  s_cmp_ge_u32 s2, 256
  s_cbranch_scc1 L_oproj_kernel_end
  s_load_dwordx2 s[16:17], s[0:1], 64
  s_load_dwordx2 s[14:15], s[0:1], 48
  v_lshrrev_b32 v1, 6, v0
  v_and_b32 v0, 63, v0
  s_and_b32 s20, s2, 1
  v_readfirstlane_b32 s23, v1
  s_lshr_b32 s18, s2, 3
  s_and_b32 s22, s18, 3
  s_lshr_b32 s21, s18, 2
  s_and_b32 s19, s2, 6
  s_lshl_b32 s19, s19, 2
  s_add_u32 s21, s21, s19
  s_cmp_ge_u32 s23, 5
  s_cselect_b32 s24, 1, 0
  s_mul_i32 s25, s24, 5
  s_sub_u32 s25, s23, s25
  v_lshlrev_b32 v2, 4, v0
  s_mul_i32 s29, s24, 20480
  s_lshl_b32 s27, s25, 10
  s_add_u32 s27, s27, s29
  s_lshl_b32 s26, s20, 5
  s_add_u32 s26, s26, s21
  s_mul_i32 s26, s26, 81920
  s_add_u32 s26, s26, s27
  s_mul_i32 s28, s20, 20
  s_mul_i32 s31, s22, 5
  s_add_u32 s28, s28, s31
  s_add_u32 s28, s28, s25
  s_mul_i32 s28, s28, 40960
  s_add_u32 s28, s28, s29
  s_mov_b32 m0, s27
  s_setprio 3
  s_waitcnt lgkmcnt(0)
  s_add_u32 s32, s16, 0x1000000
  s_addc_u32 s33, s17, 0
  s_mov_b32 s34, 0x500000
  s_mov_b32 s35, 0x20000
  s_add_u32 s36, s16, 0x1600000
  s_addc_u32 s37, s17, 0
  s_mov_b32 s38, 0x190000
  s_mov_b32 s39, 0x20000
  buffer_load_dwordx4 v2, s[32:35], s26 offen lds
  s_add_u32 m0, s27, 40960
  s_add_u32 s31, s26, 40960
  buffer_load_dwordx4 v2, s[32:35], s31 offen lds
  s_barrier
  s_add_u32 s30, s28, 0
  buffer_load_dwordx4 v[32:35], v2, s[36:39], s30 offen offset:0
  s_add_u32 m0, s27, 5120
  s_add_u32 s31, s26, 5120
  buffer_load_dwordx4 v2, s[32:35], s31 offen lds
  s_add_u32 m0, s27, 46080
  s_add_u32 s31, s26, 46080
  buffer_load_dwordx4 v2, s[32:35], s31 offen lds
  buffer_load_dwordx4 v[36:39], v2, s[36:39], s30 offen offset:1024
  s_add_u32 m0, s27, 10240
  s_add_u32 s31, s26, 10240
  buffer_load_dwordx4 v2, s[32:35], s31 offen lds
  s_add_u32 m0, s27, 51200
  s_add_u32 s31, s26, 51200
  buffer_load_dwordx4 v2, s[32:35], s31 offen lds
  buffer_load_dwordx4 v[40:43], v2, s[36:39], s30 offen offset:2048
  s_add_u32 m0, s27, 15360
  s_add_u32 s31, s26, 15360
  buffer_load_dwordx4 v2, s[32:35], s31 offen lds
  s_add_u32 m0, s27, 56320
  s_add_u32 s31, s26, 56320
  buffer_load_dwordx4 v2, s[32:35], s31 offen lds
  s_mov_b32 s40, s14
  s_mov_b32 s41, s15
  s_mov_b32 s42, 0x500000
  s_mov_b32 s43, 0x20000
  v_add_u32 v3, s29, v2
  s_lshl_b32 s46, s23, 12
  s_add_u32 s46, s46, 81920
  v_add_u32 v6, s46, v2
  s_mul_i32 s47, s24, -40960
  s_add_u32 s47, s47, 20480
  s_add_u32 s46, s46, s47
  v_add_u32 v7, s46, v2
  v_and_b32 v4, 31, v0
  v_lshrrev_b32 v5, 4, v0
  v_and_b32 v5, 2, v5
  v_bfe_u32 v10, v0, 2, 2
  v_xor_b32 v5, v5, v10
  v_lshl_add_u32 v4, v4, 6, s46
  v_lshl_add_u32 v8, v5, 4, v4
  v_xor_b32 v9, 16, v8
  v_lshrrev_b32 v4, 4, v0
  v_xor_b32 v4, v4, v0
  v_lshl_add_u32 v12, v4, 4, s46
  v_lshrrev_b32 v4, 2, v0
  v_mul_u32_u24 v4, 2560, v4
  v_and_b32 v5, 3, v0
  v_lshl_add_u32 v16, v5, 4, v4
  s_lshl_b32 s44, s21, 1
  s_add_u32 s44, s44, s24
  s_mul_i32 s44, s44, 81920
  s_mul_i32 s45, s20, 1280
  s_add_u32 s44, s44, s45
  s_mul_i32 s45, s22, 320
  s_add_u32 s44, s44, s45
  s_lshl_b32 s45, s25, 6
  s_add_u32 s44, s44, s45
  s_add_u32 s45, s44, 40960
  s_waitcnt vmcnt(9)
  s_barrier
  ds_read_b128 v[144:147], v3 offset:0
  ds_read_b128 v[148:151], v3 offset:40960
  ds_read_b128 v[152:155], v3 offset:1024
  ds_read_b128 v[156:159], v3 offset:41984
  ds_read_b128 v[160:163], v3 offset:2048
  ds_read_b128 v[164:167], v3 offset:43008
  s_waitcnt vmcnt(8) lgkmcnt(4)
  v_mfma_f32_32x32x16_bf16 v[112:127], v[32:35], v[144:147], 0
  v_mfma_f32_32x32x16_bf16 v[128:143], v[32:35], v[148:151], 0
  ds_read_b128 v[144:147], v3 offset:3072
  ds_read_b128 v[148:151], v3 offset:44032
  s_waitcnt vmcnt(5) lgkmcnt(4)
  v_mfma_f32_32x32x16_bf16 v[112:127], v[36:39], v[152:155], v[112:127]
  v_mfma_f32_32x32x16_bf16 v[128:143], v[36:39], v[156:159], v[128:143]
  buffer_load_dwordx4 v[44:47], v2, s[36:39], s30 offen offset:3072
  ds_read_b128 v[152:155], v3 offset:4096
  ds_read_b128 v[156:159], v3 offset:45056
  s_waitcnt vmcnt(3) lgkmcnt(4)
  v_mfma_f32_32x32x16_bf16 v[112:127], v[40:43], v[160:163], v[112:127]
  v_mfma_f32_32x32x16_bf16 v[128:143], v[40:43], v[164:167], v[128:143]
  s_add_u32 s30, s28, 4096
  buffer_load_dwordx4 v[48:51], v2, s[36:39], s30 offen offset:0
  buffer_load_dwordx4 v[52:55], v2, s[36:39], s30 offen offset:1024
  buffer_load_dwordx4 v[56:59], v2, s[36:39], s30 offen offset:2048
  s_waitcnt vmcnt(4)
  s_barrier
  ds_read_b128 v[160:163], v3 offset:5120
  ds_read_b128 v[164:167], v3 offset:46080
  s_waitcnt vmcnt(3) lgkmcnt(4)
  v_mfma_f32_32x32x16_bf16 v[112:127], v[44:47], v[144:147], v[112:127]
  v_mfma_f32_32x32x16_bf16 v[128:143], v[44:47], v[148:151], v[128:143]
  buffer_load_dwordx4 v[60:63], v2, s[36:39], s30 offen offset:3072
  ds_read_b128 v[144:147], v3 offset:6144
  ds_read_b128 v[148:151], v3 offset:47104
  s_waitcnt vmcnt(3) lgkmcnt(4)
  v_mfma_f32_32x32x16_bf16 v[112:127], v[48:51], v[152:155], v[112:127]
  v_mfma_f32_32x32x16_bf16 v[128:143], v[48:51], v[156:159], v[128:143]
  s_add_u32 s30, s28, 8192
  buffer_load_dwordx4 v[64:67], v2, s[36:39], s30 offen offset:0
  ds_read_b128 v[152:155], v3 offset:7168
  ds_read_b128 v[156:159], v3 offset:48128
  s_waitcnt vmcnt(3) lgkmcnt(4)
  v_mfma_f32_32x32x16_bf16 v[112:127], v[52:55], v[160:163], v[112:127]
  v_mfma_f32_32x32x16_bf16 v[128:143], v[52:55], v[164:167], v[128:143]
  buffer_load_dwordx4 v[68:71], v2, s[36:39], s30 offen offset:1024
  ds_read_b128 v[160:163], v3 offset:8192
  ds_read_b128 v[164:167], v3 offset:49152
  s_waitcnt vmcnt(3) lgkmcnt(4)
  v_mfma_f32_32x32x16_bf16 v[112:127], v[56:59], v[144:147], v[112:127]
  v_mfma_f32_32x32x16_bf16 v[128:143], v[56:59], v[148:151], v[128:143]
  buffer_load_dwordx4 v[72:75], v2, s[36:39], s30 offen offset:2048
  ds_read_b128 v[144:147], v3 offset:9216
  ds_read_b128 v[148:151], v3 offset:50176
  s_waitcnt vmcnt(3) lgkmcnt(4)
  v_mfma_f32_32x32x16_bf16 v[112:127], v[60:63], v[152:155], v[112:127]
  v_mfma_f32_32x32x16_bf16 v[128:143], v[60:63], v[156:159], v[128:143]
  s_setprio 2
  buffer_load_dwordx4 v[76:79], v2, s[36:39], s30 offen offset:3072
  ds_read_b128 v[152:155], v3 offset:10240
  ds_read_b128 v[156:159], v3 offset:51200
  s_waitcnt vmcnt(3) lgkmcnt(4)
  v_mfma_f32_32x32x16_bf16 v[112:127], v[64:67], v[160:163], v[112:127]
  v_mfma_f32_32x32x16_bf16 v[128:143], v[64:67], v[164:167], v[128:143]
  s_add_u32 s30, s28, 12288
  buffer_load_dwordx4 v[80:83], v2, s[36:39], s30 offen offset:0
  ds_read_b128 v[160:163], v3 offset:11264
  ds_read_b128 v[164:167], v3 offset:52224
  s_waitcnt vmcnt(3) lgkmcnt(4)
  v_mfma_f32_32x32x16_bf16 v[112:127], v[68:71], v[144:147], v[112:127]
  v_mfma_f32_32x32x16_bf16 v[128:143], v[68:71], v[148:151], v[128:143]
  buffer_load_dwordx4 v[84:87], v2, s[36:39], s30 offen offset:1024
  ds_read_b128 v[144:147], v3 offset:12288
  ds_read_b128 v[148:151], v3 offset:53248
  s_waitcnt vmcnt(3) lgkmcnt(4)
  v_mfma_f32_32x32x16_bf16 v[112:127], v[72:75], v[152:155], v[112:127]
  v_mfma_f32_32x32x16_bf16 v[128:143], v[72:75], v[156:159], v[128:143]
  buffer_load_dwordx4 v[88:91], v2, s[36:39], s30 offen offset:2048
  ds_read_b128 v[152:155], v3 offset:13312
  ds_read_b128 v[156:159], v3 offset:54272
  s_waitcnt vmcnt(3) lgkmcnt(4)
  v_mfma_f32_32x32x16_bf16 v[112:127], v[76:79], v[160:163], v[112:127]
  v_mfma_f32_32x32x16_bf16 v[128:143], v[76:79], v[164:167], v[128:143]
  s_setprio 1
  buffer_load_dwordx4 v[92:95], v2, s[36:39], s30 offen offset:3072
  ds_read_b128 v[160:163], v3 offset:14336
  ds_read_b128 v[164:167], v3 offset:55296
  s_waitcnt vmcnt(3) lgkmcnt(4)
  v_mfma_f32_32x32x16_bf16 v[112:127], v[80:83], v[144:147], v[112:127]
  v_mfma_f32_32x32x16_bf16 v[128:143], v[80:83], v[148:151], v[128:143]
  s_add_u32 s30, s28, 16384
  buffer_load_dwordx4 v[96:99], v2, s[36:39], s30 offen offset:0
  ds_read_b128 v[144:147], v3 offset:15360
  ds_read_b128 v[148:151], v3 offset:56320
  s_waitcnt vmcnt(3) lgkmcnt(4)
  v_mfma_f32_32x32x16_bf16 v[112:127], v[84:87], v[152:155], v[112:127]
  v_mfma_f32_32x32x16_bf16 v[128:143], v[84:87], v[156:159], v[128:143]
  buffer_load_dwordx4 v[100:103], v2, s[36:39], s30 offen offset:1024
  ds_read_b128 v[152:155], v3 offset:16384
  ds_read_b128 v[156:159], v3 offset:57344
  s_waitcnt vmcnt(3) lgkmcnt(4)
  v_mfma_f32_32x32x16_bf16 v[112:127], v[88:91], v[160:163], v[112:127]
  v_mfma_f32_32x32x16_bf16 v[128:143], v[88:91], v[164:167], v[128:143]
  buffer_load_dwordx4 v[104:107], v2, s[36:39], s30 offen offset:2048
  ds_read_b128 v[160:163], v3 offset:17408
  ds_read_b128 v[164:167], v3 offset:58368
  s_waitcnt vmcnt(3) lgkmcnt(4)
  v_mfma_f32_32x32x16_bf16 v[112:127], v[92:95], v[144:147], v[112:127]
  v_mfma_f32_32x32x16_bf16 v[128:143], v[92:95], v[148:151], v[128:143]
  s_setprio 0
  buffer_load_dwordx4 v[108:111], v2, s[36:39], s30 offen offset:3072
  ds_read_b128 v[144:147], v3 offset:18432
  ds_read_b128 v[148:151], v3 offset:59392
  s_waitcnt vmcnt(3) lgkmcnt(4)
  v_mfma_f32_32x32x16_bf16 v[112:127], v[96:99], v[152:155], v[112:127]
  v_mfma_f32_32x32x16_bf16 v[128:143], v[96:99], v[156:159], v[128:143]
  ds_read_b128 v[152:155], v3 offset:19456
  ds_read_b128 v[156:159], v3 offset:60416
  s_waitcnt vmcnt(2) lgkmcnt(4)
  v_mfma_f32_32x32x16_bf16 v[112:127], v[100:103], v[160:163], v[112:127]
  v_mfma_f32_32x32x16_bf16 v[128:143], v[100:103], v[164:167], v[128:143]
  s_waitcnt vmcnt(1) lgkmcnt(2)
  v_mfma_f32_32x32x16_bf16 v[112:127], v[104:107], v[144:147], v[112:127]
  v_mfma_f32_32x32x16_bf16 v[128:143], v[104:107], v[148:151], v[128:143]
  s_waitcnt vmcnt(0) lgkmcnt(0)
  v_mfma_f32_32x32x16_bf16 v[112:127], v[108:111], v[152:155], v[112:127]
  v_mfma_f32_32x32x16_bf16 v[128:143], v[108:111], v[156:159], v[128:143]
  s_cmp_eq_u32 s24, 0
  s_nop 12
  s_cbranch_scc0 L_oproj_kernel_k1
  ds_write_b128 v6, v[128:131] offset:0
  ds_write_b128 v6, v[132:135] offset:1024
  ds_write_b128 v6, v[136:139] offset:2048
  ds_write_b128 v6, v[140:143] offset:3072
  s_waitcnt lgkmcnt(0)
  s_barrier
  ds_read_b128 v[32:35], v7 offset:0
  ds_read_b128 v[36:39], v7 offset:1024
  ds_read_b128 v[40:43], v7 offset:2048
  ds_read_b128 v[44:47], v7 offset:3072
  s_waitcnt lgkmcnt(3)
  v_pk_add_f32 v[112:113], v[112:113], v[32:33]
  v_pk_add_f32 v[114:115], v[114:115], v[34:35]
  s_waitcnt lgkmcnt(2)
  v_pk_add_f32 v[116:117], v[116:117], v[36:37]
  v_pk_add_f32 v[118:119], v[118:119], v[38:39]
  s_waitcnt lgkmcnt(1)
  v_pk_add_f32 v[120:121], v[120:121], v[40:41]
  v_pk_add_f32 v[122:123], v[122:123], v[42:43]
  s_waitcnt lgkmcnt(0)
  v_pk_add_f32 v[124:125], v[124:125], v[44:45]
  v_pk_add_f32 v[126:127], v[126:127], v[46:47]
  v_cvt_pk_bf16_f32 v112, v112, v113
  v_cvt_pk_bf16_f32 v113, v114, v115
  v_cvt_pk_bf16_f32 v114, v116, v117
  v_cvt_pk_bf16_f32 v115, v118, v119
  v_cvt_pk_bf16_f32 v116, v120, v121
  v_cvt_pk_bf16_f32 v117, v122, v123
  v_cvt_pk_bf16_f32 v118, v124, v125
  v_cvt_pk_bf16_f32 v119, v126, v127
  ds_write_b128 v8, v[112:115]
  ds_write_b128 v9, v[116:119]
  ds_read_b128 v[32:35], v12 offset:0
  ds_read_b128 v[36:39], v12 offset:1024
  s_waitcnt lgkmcnt(1)
  buffer_store_dwordx4 v[32:35], v16, s[40:43], s44 offen sc1
  s_waitcnt lgkmcnt(0)
  buffer_store_dwordx4 v[36:39], v16, s[40:43], s45 offen sc1
  s_endpgm
L_oproj_kernel_k1:
  ds_write_b128 v6, v[112:115] offset:0
  ds_write_b128 v6, v[116:119] offset:1024
  ds_write_b128 v6, v[120:123] offset:2048
  ds_write_b128 v6, v[124:127] offset:3072
  s_waitcnt lgkmcnt(0)
  s_barrier
  ds_read_b128 v[32:35], v7 offset:0
  ds_read_b128 v[36:39], v7 offset:1024
  ds_read_b128 v[40:43], v7 offset:2048
  ds_read_b128 v[44:47], v7 offset:3072
  s_waitcnt lgkmcnt(3)
  v_pk_add_f32 v[128:129], v[128:129], v[32:33]
  v_pk_add_f32 v[130:131], v[130:131], v[34:35]
  s_waitcnt lgkmcnt(2)
  v_pk_add_f32 v[132:133], v[132:133], v[36:37]
  v_pk_add_f32 v[134:135], v[134:135], v[38:39]
  s_waitcnt lgkmcnt(1)
  v_pk_add_f32 v[136:137], v[136:137], v[40:41]
  v_pk_add_f32 v[138:139], v[138:139], v[42:43]
  s_waitcnt lgkmcnt(0)
  v_pk_add_f32 v[140:141], v[140:141], v[44:45]
  v_pk_add_f32 v[142:143], v[142:143], v[46:47]
  v_cvt_pk_bf16_f32 v128, v128, v129
  v_cvt_pk_bf16_f32 v129, v130, v131
  v_cvt_pk_bf16_f32 v130, v132, v133
  v_cvt_pk_bf16_f32 v131, v134, v135
  v_cvt_pk_bf16_f32 v132, v136, v137
  v_cvt_pk_bf16_f32 v133, v138, v139
  v_cvt_pk_bf16_f32 v134, v140, v141
  v_cvt_pk_bf16_f32 v135, v142, v143
  ds_write_b128 v8, v[128:131]
  ds_write_b128 v9, v[132:135]
  ds_read_b128 v[32:35], v12 offset:0
  ds_read_b128 v[36:39], v12 offset:1024
  s_waitcnt lgkmcnt(1)
  buffer_store_dwordx4 v[32:35], v16, s[40:43], s44 offen sc1
  s_waitcnt lgkmcnt(0)
  buffer_store_dwordx4 v[36:39], v16, s[40:43], s45 offen sc1
  s_endpgm
L_oproj_kernel_end:
  s_endpgm
.section .rodata,"a"
.p2align 6
.amdhsa_kernel qkv_kernel
  .amdhsa_next_free_vgpr 256
  .amdhsa_next_free_sgpr 96
  .amdhsa_accum_offset 256
  .amdhsa_group_segment_fixed_size 0
  .amdhsa_kernarg_size 72
  .amdhsa_user_sgpr_count 2
  .amdhsa_user_sgpr_kernarg_segment_ptr 1
  .amdhsa_system_sgpr_workgroup_id_x 1
.end_amdhsa_kernel
.p2align 6
.amdhsa_kernel attn_kernel
  .amdhsa_next_free_vgpr 256
  .amdhsa_next_free_sgpr 96
  .amdhsa_accum_offset 256
  .amdhsa_group_segment_fixed_size 0
  .amdhsa_kernarg_size 72
  .amdhsa_user_sgpr_count 2
  .amdhsa_user_sgpr_kernarg_segment_ptr 1
  .amdhsa_system_sgpr_workgroup_id_x 1
.end_amdhsa_kernel
.p2align 6
.amdhsa_kernel oproj_kernel
  .amdhsa_next_free_vgpr 168
  .amdhsa_next_free_sgpr 96
  .amdhsa_accum_offset 168
  .amdhsa_group_segment_fixed_size 0
  .amdhsa_kernarg_size 72
  .amdhsa_user_sgpr_count 2
  .amdhsa_user_sgpr_kernarg_segment_ptr 1
  .amdhsa_system_sgpr_workgroup_id_x 1
.end_amdhsa_kernel
```
